```python
import torch

def _softmax(x, axis=-1):
    return torch.softmax(x, dim=axis)
def _gelu(x):
    return torch.nn.functional.gelu(x, approximate="tanh")
def _silu(x):
    return torch.nn.functional.silu(x)
def _sigmoid(x):
    return torch.sigmoid(x)
def _layernorm(x, axis=-1, eps=1e-5):
    m = x.mean(dim=axis, keepdim=True)
    v = x.var(dim=axis, keepdim=True, unbiased=False)
    return (x - m) / torch.sqrt(v + eps)
def _scatter_add(tgt, idx, src, axis=0):
    return tgt.clone().index_add_(axis, idx, src)
def _segment_sum(src, seg, n):
    out = torch.zeros((n,) + src.shape[1:], dtype=src.dtype)
    return out.index_add_(0, seg, src)
def _pad(x, pw):
    flat = tuple(v for pair in reversed(pw) for v in pair)
    return torch.nn.functional.pad(x, flat)

kernel_name = 'gated_mix__softmax_full_mha__mixer_token_mlp__prompt'

def setup_inputs():

    _w = (lambda a: (lambda t: t.to(torch.bfloat16) if t.is_floating_point() else t)(torch.as_tensor(a)))
    def _A_setup():
        B, S, D = 1, 2048, 512
        return {
            "x": _w((lambda *s: torch.randn(*s, dtype=torch.bfloat16) * 0.05)(B, S, D)),
            "wqkv": _w((lambda *s: torch.randn(*s, dtype=torch.bfloat16) * 0.8)(D, 3 * D)),
            "wo": _w((lambda *s: torch.randn(*s, dtype=torch.bfloat16) * 0.05)(D, D)),
        }
    _A_in = _A_setup()

    def _B_setup():
        B, S, D, F = 1, 2048, 512, 1792
        return {
            "x": _w((lambda *s: torch.randn(*s, dtype=torch.bfloat16) * 0.05)(B, S, D)),
            "w1": _w((lambda *s: torch.randn(*s, dtype=torch.bfloat16) * 0.8)(S, F) * (S ** -0.5)),
            "b1": _w((lambda *s: torch.randn(*s, dtype=torch.bfloat16) * 12.8)(F) * 0.02),
            "w2": _w((lambda *s: torch.randn(*s, dtype=torch.bfloat16) * 0.05)(F, S) * (F ** -0.5)),
            "b2": _w((lambda *s: torch.randn(*s, dtype=torch.bfloat16) * 0.8)(S) * 0.02),
        }
    _B_in = _B_setup()

    return {
        "A_x": _A_in["x"],
        "A_wqkv": _A_in["wqkv"],
        "A_wo": _A_in["wo"],
        "B_x": _B_in["x"],
        "B_w1": _B_in["w1"],
        "B_b1": _B_in["b1"],
        "B_w2": _B_in["w2"],
        "B_b2": _B_in["b2"],
        "gate_w": _w((lambda *s: torch.randn(*s, dtype=torch.bfloat16) * 0.05)(512) * 16.0),
    }

def reference(A_x, A_wqkv, A_wo, B_x, B_w1, B_b1, B_w2, B_b2, gate_w):
    def _A_ref(x, wqkv, wo):
        B, S, D = x.shape
        H = 32; Dh = D // H
        qkv = (lambda x, *d: x.permute(*d))((x @ wqkv).reshape(B, S, 3, H, Dh), 2, 0, 3, 1, 4)
        q, k, v = qkv[0], qkv[1], qkv[2]
        scale = Dh ** -0.5
        scores = torch.einsum("bhqd,bhkd->bhqk", q, k) * scale
        p = _softmax(scores, axis=-1)
        o = torch.einsum("bhqk,bhkd->bhqd", p, v)
        return (lambda x, *d: x.permute(*d))(o, 0, 2, 1, 3).reshape(B, S, D) @ wo

    def _B_ref(x, w1, b1, w2, b2):
        B, S, D = x.shape
        h = _layernorm(x, axis=-1)
        u = torch.einsum("bsd,sf->bdf", h, w1) + b1
        u = _gelu(u)
        y = torch.einsum("bdf,fs->bds", u, w2) + b2
        return (lambda x, *d: x.permute(*d))(y, 0, 2, 1)

    x = A_x
    g = _sigmoid((x * gate_w).sum(-1, keepdims=True))
    a = _A_ref(x, A_wqkv, A_wo)
    b = _B_ref(x, B_w1, B_b1, B_w2, B_b2)
    return g * a + (1 - g) * b
```

```asm
; @launch grid=(256,1,1) block=(768,1,1) lds=163840
.amdgcn_target "amdgcn-amd-amdhsa--gfx950"
.text
    .globl gated_mix__softmax_full_mha__mixer_token_mlp__prompt_kernel
    .p2align 8
    .type gated_mix__softmax_full_mha__mixer_token_mlp__prompt_kernel,@function
gated_mix__softmax_full_mha__mixer_token_mlp__prompt_kernel:
    s_load_dwordx16 s[16:31], s[0:1], 0
    s_load_dwordx8 s[32:39], s[0:1], 64
    s_cmp_ge_u32 s2, 256
    s_cbranch_scc1 M_exit
    v_lshrrev_b32 v1, 6, v0
    v_and_b32 v0, 63, v0
    s_mov_b32 s48, 0x40000
    v_readfirstlane_b32 s3, v1
    s_nop 1
    s_cmp_ge_u32 s3, 8
    s_cbranch_scc1 M_g
    s_cmp_lt_u32 s3, 4
    s_cbranch_scc1 M_c
    s_and_b32 s61, s2, 7
    s_lshr_b32 s60, s2, 3
    s_lshr_b32 s54, s60, 3
    s_lshl1_add_u32 s62, s54, s60
    s_add_u32 s62, s62, s61
    s_and_b32 s62, s62, 7
    s_sub_u32 s71, s3, 4
    v_lshrrev_b32 v1, 3, v0
    v_and_b32 v2, 7, v0
    v_lshrrev_b32 v3, 4, v0
    v_xor_b32 v4, v2, v3
    v_xor_b32 v5, 4, v4
    v_lshlrev_b32 v4, 4, v4
    v_lshl_add_u32 v4, v1, 10, v4
    v_lshlrev_b32 v5, 4, v5
    v_lshl_add_u32 v5, v1, 10, v5
    v_add_u32 v5, 7168, v5
    v_and_b32 v3, 1, v3
    v_lshlrev_b32 v3, 1, v3
    v_xor_b32 v2, v2, v3
    v_mul_u32_u24 v6, 3072, v1
    v_lshl_add_u32 v6, v2, 4, v6
    v_xor_b32 v7, 64, v6
    v_add_u32 v7, 23552, v7
    s_lshl_b32 s66, s60, 16
    s_lshl_b32 s52, s71, 14
    s_add_u32 s66, s66, s52
    s_mul_i32 s68, s71, 49152
    s_lshl_b32 s52, s61, 7
    s_add_u32 s68, s68, s52
    s_lshl_b32 s67, s71, 11
    s_mul_i32 s69, s71, 6144
    s_add_u32 s69, s69, 8192
    s_mov_b32 s72, 0
    s_lshl_b32 s52, s62, 7
    s_add_u32 s66, s66, s52
    s_mul_i32 s52, s62, 196608
    s_add_u32 s68, s68, s52
    s_mov_b32 s10, 2097152
    s_mov_b32 s11, 0x00020000
    s_mov_b32 s14, 1572864
    s_mov_b32 s15, 0x00020000
    s_waitcnt lgkmcnt(0)
    s_add_u32 s52, s38, 13651968
    s_addc_u32 s53, s39, 0
    s_load_dword s49, s[52:53], 0
    s_mov_b64 s[8:9], s[16:17]
    s_mov_b64 s[12:13], s[18:19]
QL_1:
    s_cmp_lg_u32 s62, 8
    s_cbranch_scc1 QL_3
    s_sub_u32 s66, s66, 1024
    s_sub_u32 s68, s68, 1572864
QL_3:
    s_add_u32 s62, s62, 1
    s_mov_b32 m0, s67
    s_add_u32 s67, s67, 32768
    buffer_load_dwordx4 v4, s[8:11], s66 offen lds
    buffer_load_dwordx4 v5, s[8:11], s66 offen offset:1024 lds
    s_mov_b32 m0, s69
    s_add_u32 s66, s66, 128
    buffer_load_dwordx4 v6, s[12:15], s68 offen lds
    buffer_load_dwordx4 v7, s[12:15], s68 offen offset:1024 lds
    s_add_u32 m0, s69, 1024
    s_and_b32 s67, s67, 0x1ffff
    buffer_load_dwordx4 v6, s[12:15], s68 offen offset:1024 lds
    buffer_load_dwordx4 v7, s[12:15], s68 offen offset:2048 lds
    s_add_u32 m0, s69, 2048
    s_add_u32 s69, s69, 32768
    buffer_load_dwordx4 v6, s[12:15], s68 offen offset:2048 lds
    buffer_load_dwordx4 v7, s[12:15], s68 offen offset:3072 lds
    s_and_b32 s69, s69, 0x1ffff
    s_add_u32 s68, s68, 196608
    s_add_u32 s72, s72, 1
    s_cmp_lt_u32 s72, 2
    s_cbranch_scc1 QL_1
    s_cmp_lg_u32 s72, 2
    s_cbranch_scc1 QL_4
    s_lshl_b32 s52, s3, 2
    s_add_u32 s52, s52, 163776
    v_mov_b32 v104, 262144
    v_mov_b32 v105, s52
    v_cmp_eq_u32 vcc, 0, v0
    s_nop 1
    v_cndmask_b32 v104, v104, v105, vcc
    v_and_b32 v105, 3, v0
    v_lshlrev_b32 v105, 2, v105
    v_add_u32 v105, 163776, v105
    s_mov_b32 s4, s38
    s_mov_b32 s5, s39
    s_mov_b32 s6, 16777216
    s_mov_b32 s7, 0x00020000
    s_waitcnt lgkmcnt(0)
    s_add_u32 s49, s49, 0x9E3779B9
    s_barrier
QL_4:
    s_sub_u32 s73, s72, 1
    s_waitcnt vmcnt(8)
    v_mov_b32 v1, s73
    ds_write_b32 v104, v1
    s_cmp_eq_u32 s72, 8
    s_cbranch_scc1 QL_5
    s_cmp_lt_u32 s72, 4
    s_cbranch_scc1 QL_1
    s_sub_u32 s73, s72, 3
W_6:
    ds_read_b32 v1, v105
    s_waitcnt lgkmcnt(0)
    v_cmp_gt_u32 vcc, s73, v1
    s_cbranch_vccz W_7
    s_sub_u32 s48, s48, 1
    s_cbranch_scc0 W_6
    s_mov_b32 s48, 0
W_7:
    s_branch QL_1
QL_5:
    s_waitcnt vmcnt(0)
    v_mov_b32 v1, 10
    ds_write_b32 v104, v1
    s_mov_b32 s4, s38
    s_mov_b32 s5, s39
    s_mov_b32 s6, 16777216
    s_mov_b32 s7, 0x00020000
    s_branch M_attn
M_c:
    s_and_b32 s61, s2, 7
    s_lshr_b32 s60, s2, 3
    s_lshr_b32 s54, s60, 3
    s_lshl1_add_u32 s62, s54, s60
    s_add_u32 s62, s62, s61
    s_and_b32 s62, s62, 7
    v_and_b32 v1, 15, v0
    v_lshrrev_b32 v2, 4, v0
    v_bfe_u32 v3, v0, 1, 3
    v_xor_b32 v3, v3, v2
    v_lshlrev_b32 v3, 4, v3
    v_lshl_add_u32 v4, v1, 7, v3
    v_xor_b32 v5, 64, v4
    v_bfe_u32 v1, v0, 2, 2
    v_bfe_u32 v3, v0, 4, 1
    v_lshl_add_u32 v7, v3, 3, v1
    v_lshlrev_b32 v6, 7, v7
    v_lshrrev_b32 v1, 1, v1
    v_lshl_or_b32 v1, v3, 1, v1
    v_xor_b32 v1, s3, v1
    v_lshl_add_u32 v6, v1, 5, v6
    v_and_b32 v1, 3, v0
    v_lshl_add_u32 v6, v1, 3, v6
    v_lshrrev_b32 v1, 5, v0
    v_mul_u32_u24 v1, 6144, v1
    v_add_u32 v6, v1, v6
    v_add_u32 v6, 8192, v6
    v_mov_b32 v108, 0
    v_mov_b32 v109, 0
    v_mov_b32 v110, 0
    v_mov_b32 v111, 0
    v_mov_b32 v112, 0
    v_mov_b32 v113, 0
    v_mov_b32 v114, 0
    v_mov_b32 v115, 0
    v_mov_b32 v116, 0
    v_mov_b32 v117, 0
    v_mov_b32 v118, 0
    v_mov_b32 v119, 0
    v_mov_b32 v120, 0
    v_mov_b32 v121, 0
    v_mov_b32 v122, 0
    v_mov_b32 v123, 0
    v_mov_b32 v124, 0
    v_mov_b32 v125, 0
    v_mov_b32 v126, 0
    v_mov_b32 v127, 0
    v_mov_b32 v128, 0
    v_mov_b32 v129, 0
    v_mov_b32 v130, 0
    v_mov_b32 v131, 0
    v_mov_b32 v132, 0
    v_mov_b32 v133, 0
    v_mov_b32 v134, 0
    v_mov_b32 v135, 0
    v_mov_b32 v136, 0
    v_mov_b32 v137, 0
    v_mov_b32 v138, 0
    v_mov_b32 v139, 0
    v_mov_b32 v140, 0
    v_mov_b32 v141, 0
    v_mov_b32 v142, 0
    v_mov_b32 v143, 0
    v_mov_b32 v144, 0
    v_mov_b32 v145, 0
    v_mov_b32 v146, 0
    v_mov_b32 v147, 0
    v_mov_b32 v148, 0
    v_mov_b32 v149, 0
    v_mov_b32 v150, 0
    v_mov_b32 v151, 0
    v_mov_b32 v152, 0
    v_mov_b32 v153, 0
    v_mov_b32 v154, 0
    v_mov_b32 v155, 0
    s_lshl_b32 s52, s3, 2
    s_add_u32 s52, s52, 163776
    v_mov_b32 v104, 262144
    v_mov_b32 v105, s52
    v_cmp_eq_u32 vcc, 0, v0
    s_nop 1
    v_cndmask_b32 v104, v104, v105, vcc
    v_and_b32 v105, 3, v0
    v_lshlrev_b32 v105, 2, v105
    v_add_u32 v105, 163792, v105
    s_waitcnt lgkmcnt(0)
    s_add_u32 s52, s38, 13651968
    s_addc_u32 s53, s39, 0
    s_load_dword s49, s[52:53], 0
    s_mov_b32 s4, s38
    s_mov_b32 s5, s39
    s_mov_b32 s6, 16777216
    s_mov_b32 s7, 0x00020000
    s_waitcnt lgkmcnt(0)
    s_add_u32 s49, s49, 0x9E3779B9
    s_barrier
    s_mov_b32 s72, 1
W_8:
    ds_read_b32 v1, v105
    s_waitcnt lgkmcnt(0)
    v_cmp_gt_u32 vcc, 1, v1
    s_cbranch_vccz W_9
    s_sub_u32 s48, s48, 1
    s_cbranch_scc0 W_8
    s_mov_b32 s48, 0
W_9:
    ds_read_b128 v[8:11], v4 offset:0
    ds_read_b64_tr_b16 v[24:25], v6 offset:0
    ds_read_b64_tr_b16 v[26:27], v6 offset:512
    ds_read_b128 v[12:15], v4 offset:2048
    ds_read_b64_tr_b16 v[28:29], v6 offset:2048
    ds_read_b64_tr_b16 v[30:31], v6 offset:2560
    ds_read_b128 v[16:19], v4 offset:4096
    ds_read_b64_tr_b16 v[32:33], v6 offset:4096
    ds_read_b64_tr_b16 v[34:35], v6 offset:4608
    ds_read_b128 v[20:23], v4 offset:6144
QC_10:
    v_mov_b32 v1, s72
    s_waitcnt lgkmcnt(0)
    v_mfma_f32_16x16x32_bf16 v[108:111], v[24:27], v[8:11], v[108:111]
    ds_read_b128 v[36:39], v5 offset:0
    ds_read_b64_tr_b16 v[52:53], v6 offset:12288
    v_mfma_f32_16x16x32_bf16 v[124:127], v[28:31], v[8:11], v[124:127]
    ds_read_b64_tr_b16 v[54:55], v6 offset:12800
    ds_read_b128 v[40:43], v5 offset:2048
    v_mfma_f32_16x16x32_bf16 v[140:143], v[8:11], v[32:35], v[140:143]
    ds_read_b64_tr_b16 v[56:57], v6 offset:14336
    ds_read_b64_tr_b16 v[58:59], v6 offset:14848
    v_mfma_f32_16x16x32_bf16 v[112:115], v[24:27], v[12:15], v[112:115]
    ds_read_b128 v[44:47], v5 offset:4096
    ds_read_b64_tr_b16 v[60:61], v6 offset:16384
    v_mfma_f32_16x16x32_bf16 v[128:131], v[28:31], v[12:15], v[128:131]
    ds_read_b64_tr_b16 v[62:63], v6 offset:16896
    ds_read_b128 v[48:51], v5 offset:6144
    v_mfma_f32_16x16x32_bf16 v[144:147], v[12:15], v[32:35], v[144:147]
    ds_write_b32 v104, v1
    v_mfma_f32_16x16x32_bf16 v[116:119], v[24:27], v[16:19], v[116:119]
    ds_read_b32 v2, v105
    v_mfma_f32_16x16x32_bf16 v[132:135], v[28:31], v[16:19], v[132:135]
    s_mov_b32 s52, 32768
    s_cmp_eq_u32 s72, 4
    s_cselect_b32 s52, 4294868992, s52
    s_add_u32 s72, s72, 1
    s_min_u32 s63, s72, 8
    v_mfma_f32_16x16x32_bf16 v[148:151], v[16:19], v[32:35], v[148:151]
    v_add_u32 v4, s52, v4
    v_mfma_f32_16x16x32_bf16 v[120:123], v[24:27], v[20:23], v[120:123]
    v_add_u32 v5, s52, v5
    v_mfma_f32_16x16x32_bf16 v[136:139], v[28:31], v[20:23], v[136:139]
    v_add_u32 v6, s52, v6
    v_mfma_f32_16x16x32_bf16 v[152:155], v[20:23], v[32:35], v[152:155]
    s_waitcnt lgkmcnt(0)
    v_cmp_gt_u32 vcc, s63, v2
    s_cbranch_vccnz QC_11
    v_mfma_f32_16x16x32_bf16 v[108:111], v[52:55], v[36:39], v[108:111]
    ds_read_b128 v[8:11], v4 offset:0
    ds_read_b64_tr_b16 v[24:25], v6 offset:0
    v_mfma_f32_16x16x32_bf16 v[124:127], v[56:59], v[36:39], v[124:127]
    ds_read_b64_tr_b16 v[26:27], v6 offset:512
    ds_read_b128 v[12:15], v4 offset:2048
    v_mfma_f32_16x16x32_bf16 v[140:143], v[36:39], v[60:63], v[140:143]
    ds_read_b64_tr_b16 v[28:29], v6 offset:2048
    ds_read_b64_tr_b16 v[30:31], v6 offset:2560
    v_mfma_f32_16x16x32_bf16 v[112:115], v[52:55], v[40:43], v[112:115]
    ds_read_b128 v[16:19], v4 offset:4096
    ds_read_b64_tr_b16 v[32:33], v6 offset:4096
    v_mfma_f32_16x16x32_bf16 v[128:131], v[56:59], v[40:43], v[128:131]
    ds_read_b64_tr_b16 v[34:35], v6 offset:4608
    ds_read_b128 v[20:23], v4 offset:6144
    v_mfma_f32_16x16x32_bf16 v[144:147], v[40:43], v[60:63], v[144:147]
    v_mfma_f32_16x16x32_bf16 v[116:119], v[52:55], v[44:47], v[116:119]
    v_mfma_f32_16x16x32_bf16 v[132:135], v[56:59], v[44:47], v[132:135]
    v_mfma_f32_16x16x32_bf16 v[148:151], v[44:47], v[60:63], v[148:151]
    v_mfma_f32_16x16x32_bf16 v[120:123], v[52:55], v[48:51], v[120:123]
    v_mfma_f32_16x16x32_bf16 v[136:139], v[56:59], v[48:51], v[136:139]
    v_mfma_f32_16x16x32_bf16 v[152:155], v[48:51], v[60:63], v[152:155]
    s_cmp_le_u32 s72, 8
    s_cbranch_scc1 QC_10
    s_branch QC_12
QC_11:
    v_mfma_f32_16x16x32_bf16 v[108:111], v[52:55], v[36:39], v[108:111]
    v_mfma_f32_16x16x32_bf16 v[124:127], v[56:59], v[36:39], v[124:127]
    v_mfma_f32_16x16x32_bf16 v[140:143], v[36:39], v[60:63], v[140:143]
    v_mfma_f32_16x16x32_bf16 v[112:115], v[52:55], v[40:43], v[112:115]
    v_mfma_f32_16x16x32_bf16 v[128:131], v[56:59], v[40:43], v[128:131]
    v_mfma_f32_16x16x32_bf16 v[144:147], v[40:43], v[60:63], v[144:147]
    v_mfma_f32_16x16x32_bf16 v[116:119], v[52:55], v[44:47], v[116:119]
    v_mfma_f32_16x16x32_bf16 v[132:135], v[56:59], v[44:47], v[132:135]
    v_mfma_f32_16x16x32_bf16 v[148:151], v[44:47], v[60:63], v[148:151]
    v_mfma_f32_16x16x32_bf16 v[120:123], v[52:55], v[48:51], v[120:123]
    v_mfma_f32_16x16x32_bf16 v[136:139], v[56:59], v[48:51], v[136:139]
    v_mfma_f32_16x16x32_bf16 v[152:155], v[48:51], v[60:63], v[152:155]
W_13:
    ds_read_b32 v2, v105
    s_waitcnt lgkmcnt(0)
    v_cmp_gt_u32 vcc, s63, v2
    s_cbranch_vccz W_14
    s_sub_u32 s48, s48, 1
    s_cbranch_scc0 W_13
    s_mov_b32 s48, 0
W_14:
    ds_read_b128 v[8:11], v4 offset:0
    ds_read_b64_tr_b16 v[24:25], v6 offset:0
    ds_read_b64_tr_b16 v[26:27], v6 offset:512
    ds_read_b128 v[12:15], v4 offset:2048
    ds_read_b64_tr_b16 v[28:29], v6 offset:2048
    ds_read_b64_tr_b16 v[30:31], v6 offset:2560
    ds_read_b128 v[16:19], v4 offset:4096
    ds_read_b64_tr_b16 v[32:33], v6 offset:4096
    ds_read_b64_tr_b16 v[34:35], v6 offset:4608
    ds_read_b128 v[20:23], v4 offset:6144
    s_branch QC_10
QC_12:
    v_mov_b32 v3, 163824
    ds_read_b32 v7, v3
    s_lshl2_add_u32 s67, s61, s3
    s_lshl_b32 s68, s67, 5
    s_add_u32 s66, s68, s60
    s_lshl_b32 s69, s66, 11
    s_lshl_b32 s68, s66, 12
    s_add_u32 s68, s68, 2097152
    v_lshlrev_b32 v4, 4, v0
    v_and_b32 v1, 15, v0
    v_lshlrev_b32 v6, 4, v1
    v_bfe_u32 v1, v0, 4, 1
    v_lshl_add_u32 v6, v1, 9, v6
    v_lshrrev_b32 v1, 5, v0
    v_lshl_add_u32 v6, v1, 8, v6
    s_mov_b32 s52, 0x3eb8aa3b
    s_mov_b32 s53, s52
    s_lshl_b32 s70, s66, 7
    s_add_u32 s70, s70, 13762560
    s_waitcnt lgkmcnt(0)
    v_cmp_ne_u32 vcc, 1, v7
    s_cbranch_vccnz QF_15
QF_16:
    v_cvt_pk_bf16_f32 v64, v124, v125
    v_cvt_pk_bf16_f32 v65, v126, v127
    v_cvt_pk_bf16_f32 v66, v128, v129
    v_cvt_pk_bf16_f32 v67, v130, v131
    v_cvt_pk_bf16_f32 v68, v132, v133
    v_cvt_pk_bf16_f32 v69, v134, v135
    v_cvt_pk_bf16_f32 v70, v136, v137
    v_cvt_pk_bf16_f32 v71, v138, v139
    s_nop 0
    v_permlane16_swap_b32 v64, v66
    v_permlane16_swap_b32 v65, v67
    v_permlane16_swap_b32 v68, v70
    v_permlane16_swap_b32 v69, v71
    buffer_store_dwordx4 v[64:67], v4, s[4:7], s68 offen
    buffer_store_dwordx4 v[68:71], v4, s[4:7], s68 offen offset:2048
    v_cvt_pk_bf16_f32 v72, v140, v141
    v_cvt_pk_bf16_f32 v73, v142, v143
    v_cvt_pk_bf16_f32 v74, v144, v145
    v_cvt_pk_bf16_f32 v75, v146, v147
    v_cvt_pk_bf16_f32 v76, v148, v149
    v_cvt_pk_bf16_f32 v77, v150, v151
    v_cvt_pk_bf16_f32 v78, v152, v153
    v_cvt_pk_bf16_f32 v79, v154, v155
    s_nop 0
    v_permlane16_swap_b32 v72, v74
    v_permlane16_swap_b32 v73, v75
    v_permlane16_swap_b32 v76, v78
    v_permlane16_swap_b32 v77, v79
    buffer_store_dwordx4 v[72:75], v6, s[4:7], s68 offen offset:1024
    buffer_store_dwordx4 v[76:79], v6, s[4:7], s68 offen offset:3072
    v_pk_mul_f32 v[108:109], v[108:109], s[52:53]
    v_pk_mul_f32 v[110:111], v[110:111], s[52:53]
    v_pk_mul_f32 v[112:113], v[112:113], s[52:53]
    v_pk_mul_f32 v[114:115], v[114:115], s[52:53]
    v_pk_mul_f32 v[116:117], v[116:117], s[52:53]
    v_pk_mul_f32 v[118:119], v[118:119], s[52:53]
    v_pk_mul_f32 v[120:121], v[120:121], s[52:53]
    v_pk_mul_f32 v[122:123], v[122:123], s[52:53]
    v_cvt_pk_bf16_f32 v80, v108, v109
    v_cvt_pk_bf16_f32 v81, v110, v111
    v_cvt_pk_bf16_f32 v82, v112, v113
    v_cvt_pk_bf16_f32 v83, v114, v115
    v_cvt_pk_bf16_f32 v84, v116, v117
    v_cvt_pk_bf16_f32 v85, v118, v119
    v_cvt_pk_bf16_f32 v86, v120, v121
    v_cvt_pk_bf16_f32 v87, v122, v123
    s_nop 0
    v_permlane16_swap_b32 v80, v82
    v_permlane16_swap_b32 v81, v83
    v_permlane16_swap_b32 v84, v86
    v_permlane16_swap_b32 v85, v87
    buffer_store_dwordx4 v[80:83], v4, s[4:7], s69 offen
    buffer_store_dwordx4 v[84:87], v4, s[4:7], s69 offen offset:1024
    v_mov_b32 v1, s49
    v_cmp_eq_u32 vcc, 0, v0
    v_mov_b32 v2, 0x7ffffff0
    s_nop 0
    v_cndmask_b32 v2, v2, 0, vcc
    s_waitcnt vmcnt(0)
    buffer_store_dword v1, v2, s[4:7], s70 offen
    v_mov_b32 v1, 10
    ds_write_b32 v104, v1
    s_waitcnt lgkmcnt(0)
M_attn:
    s_and_b32 s52, s2, 7
    s_lshr_b32 s53, s2, 3
    s_and_b32 s60, s53, 3
    s_lshl2_add_u32 s60, s52, s60
    s_lshr_b32 s61, s53, 2
    s_lshl3_add_u32 s66, s61, s3
    s_lshl_b32 s63, s60, 17
    s_add_u32 s63, s63, 2097152
    s_lshl_b32 s52, s3, 11
    s_add_u32 s67, s63, s52
    s_mov_b32 s62, 0
    v_lshlrev_b32 v111, 4, v0
    s_lshl_b32 s68, s60, 6
    s_add_u32 s68, s68, s66
    s_lshl_b32 s68, s68, 10
    s_lshl_b32 s52, s3, 2
    s_add_u32 s52, s52, 163776
    v_mov_b32 v104, 262144
    v_mov_b32 v105, s52
    v_cmp_eq_u32 vcc, 0, v0
    s_nop 1
    v_cndmask_b32 v104, v104, v105, vcc
    v_and_b32 v105, 7, v0
    v_lshlrev_b32 v105, 2, v105
    v_add_u32 v105, 163776, v105
    v_and_b32 v1, 31, v0
    v_lshlrev_b32 v114, 2, v1
    s_lshl_b32 s70, s66, 7
    s_add_u32 s70, s70, 12582912
    s_cmp_eq_u32 s3, 7
    s_cbranch_scc0 AW_17
    s_lshl_b32 s52, s60, 12
    s_add_u32 s52, s52, 13762560
    s_lshl_b32 s53, s61, 12
    s_add_u32 s53, s53, 13692928
    v_mov_b32 v1, s52
    v_mov_b32 v2, s53
    v_cmp_gt_u32 vcc, 32, v0
    s_nop 1
    v_cndmask_b32 v1, v2, v1, vcc
    v_lshl_add_u32 v1, v0, 7, v1
GW_19:
    buffer_load_dword v2, v1, s[4:7], 0 offen sc1
    s_waitcnt vmcnt(0)
    v_cmp_ne_u32 vcc, s49, v2
    s_cbranch_vccz GW_20
    s_sleep 1
    s_sub_u32 s48, s48, 1
    s_cbranch_scc0 GW_19
    s_mov_b32 s48, 0
GW_20:
W_21:
    ds_read_b32 v2, v105
    s_waitcnt lgkmcnt(0)
    v_cmp_gt_u32 vcc, 10, v2
    s_cbranch_vccz W_22
    s_sub_u32 s48, s48, 1
    s_cbranch_scc0 W_21
    s_mov_b32 s48, 0
W_22:
    v_mov_b32 v2, 11
    ds_write_b32 v104, v2
    s_branch AW_18
AW_17:
    v_mov_b32 v1, 163804
W_23:
    ds_read_b32 v2, v1
    s_waitcnt lgkmcnt(0)
    v_cmp_gt_u32 vcc, 11, v2
    s_cbranch_vccz W_24
    s_sleep 2
    s_sub_u32 s48, s48, 1
    s_cbranch_scc0 W_23
    s_mov_b32 s48, 0
W_24:
AW_18:
    buffer_load_dwordx4 v[4:7], v111, s[4:7], s68 offen sc1
    s_lshl_b32 s69, s3, 11
    s_lshl_b32 s52, s62, 14
    s_mov_b32 m0, s69
    s_add_u32 s52, s52, s67
    buffer_load_dwordx4 v111, s[4:7], s52 offen sc1 lds
    buffer_load_dwordx4 v111, s[4:7], s52 offen offset:1024 sc1 lds
    s_add_u32 s62, s62, 1
    s_and_b32 s62, s62, 7
    s_add_u32 s69, s69, 16384
    s_cmp_ge_u32 s69, 81920
    s_cselect_b32 s52, 81920, 0
    s_sub_u32 s69, s69, s52
    v_mov_b32 v112, 0xdddddddd
    v_mov_b32 v107, v111
    v_and_b32 v1, 15, v0
    v_lshlrev_b32 v1, 4, v1
    v_lshrrev_b32 v2, 5, v0
    v_lshl_add_u32 v108, v2, 8, v1
    v_add_u32 v108, 1024, v108
    v_add_u32 v109, 16384, v107
    v_add_u32 v110, 16384, v108
    s_mov_b32 s50, 0x0000ffff
    s_mov_b32 s51, 0x0000ffff
    v_and_b32 v1, 31, v0
    v_cmp_eq_u32 vcc, 16, v1
    v_mov_b32 v2, 0x3f803f80
    s_nop 0
    v_cndmask_b32 v16, 0, v2, vcc
    v_mov_b32 v17, v16
    v_mov_b32 v18, v16
    v_mov_b32 v19, v16
    v_mov_b32 v20, v16
    v_mov_b32 v21, v16
    v_mov_b32 v22, v16
    v_mov_b32 v23, v16
    v_mov_b32 v24, v16
    v_mov_b32 v25, v16
    v_mov_b32 v26, v16
    v_mov_b32 v27, v16
    v_mov_b32 v28, v16
    v_mov_b32 v29, v16
    v_mov_b32 v30, v16
    v_mov_b32 v31, v16
    v_mov_b32 v72, 0
    v_mov_b32 v73, 0
    v_mov_b32 v74, 0
    v_mov_b32 v75, 0
    v_mov_b32 v76, 0
    v_mov_b32 v77, 0
    v_mov_b32 v78, 0
    v_mov_b32 v79, 0
    v_mov_b32 v80, 0
    v_mov_b32 v81, 0
    v_mov_b32 v82, 0
    v_mov_b32 v83, 0
    v_mov_b32 v84, 0
    v_mov_b32 v85, 0
    v_mov_b32 v86, 0
    v_mov_b32 v87, 0
    v_mov_b32 v32, 0
    v_mov_b32 v33, 0
    v_mov_b32 v34, 0
    v_mov_b32 v35, 0
    v_mov_b32 v36, 0
    v_mov_b32 v37, 0
    v_mov_b32 v38, 0
    v_mov_b32 v39, 0
    s_waitcnt vmcnt(0)
    v_mov_b32 v1, 12
    ds_write_b32 v104, v1
    s_lshl_b32 s52, s66, 5
    s_add_u32 s52, s52, s60
    s_lshl_b32 s73, s52, 10
    s_add_u32 s73, s73, 10485760
    s_lshl_b32 s59, s52, 7
    s_add_u32 s59, s59, 14155776
    v_mov_b32 v116, -1
    v_mov_b32 v117, -1
    v_mov_b32 v118, -1
    v_mov_b32 v119, -1
    v_cmp_eq_u32 vcc, 0, v0
    v_mov_b32 v120, s49
    v_mov_b32 v121, 0x7ffffff0
    s_nop 0
    v_cndmask_b32 v121, v121, 0, vcc
    buffer_load_dword v114, v114, s[4:7], s70 offen sc1
    s_lshl_b32 s52, s62, 14
    s_mov_b32 m0, s69
    s_add_u32 s52, s52, s67
    buffer_load_dwordx4 v111, s[4:7], s52 offen sc1 lds
    buffer_load_dwordx4 v111, s[4:7], s52 offen offset:1024 sc1 lds
    s_add_u32 s62, s62, 1
    s_and_b32 s62, s62, 7
    s_add_u32 s69, s69, 16384
    s_cmp_ge_u32 s69, 81920
    s_cselect_b32 s52, 81920, 0
    s_sub_u32 s69, s69, s52
    s_lshl_b32 s52, s62, 14
    s_mov_b32 m0, s69
    s_add_u32 s52, s52, s67
    buffer_load_dwordx4 v111, s[4:7], s52 offen sc1 lds
    buffer_load_dwordx4 v111, s[4:7], s52 offen offset:1024 sc1 lds
    s_add_u32 s62, s62, 1
    s_and_b32 s62, s62, 7
    s_add_u32 s69, s69, 16384
    s_cmp_ge_u32 s69, 81920
    s_cselect_b32 s52, 81920, 0
    s_sub_u32 s69, s69, s52
    s_lshl_b32 s52, s62, 14
    s_mov_b32 m0, s69
    s_add_u32 s52, s52, s67
    buffer_load_dwordx4 v111, s[4:7], s52 offen sc1 lds
    buffer_load_dwordx4 v111, s[4:7], s52 offen offset:1024 sc1 lds
    s_add_u32 s62, s62, 1
    s_and_b32 s62, s62, 7
    s_add_u32 s69, s69, 16384
    s_cmp_ge_u32 s69, 81920
    s_cselect_b32 s52, 81920, 0
    s_sub_u32 s69, s69, s52
W_25:
    ds_read_b32 v1, v105
    s_waitcnt lgkmcnt(0)
    v_cmp_gt_u32 vcc, 12, v1
    s_cbranch_vccz W_26
    s_sub_u32 s48, s48, 1
    s_cbranch_scc0 W_25
    s_mov_b32 s48, 0
W_26:
    ds_read_b128 v[8:11], v107
    ds_read_b128 v[12:15], v107 offset:2048
    s_mov_b64 exec, s[50:51]
    ds_read_b128 v[16:19], v108
    ds_read_b128 v[20:23], v108 offset:512
    s_mov_b64 exec, -1
    s_waitcnt lgkmcnt(3)
    v_mfma_f32_32x32x16_bf16 v[56:71], v[8:11], v[4:7], 0
    s_mov_b32 s64, 13
    s_mov_b32 s65, 0
    s_mov_b32 s71, 16384
    s_nop 9
    v_max3_f32 v1, v56, v57, v58
    v_max3_f32 v2, v59, v60, v61
    v_max3_f32 v1, v62, v63, v1
    v_max3_f32 v2, v64, v65, v2
    v_max3_f32 v1, v66, v67, v1
    v_max3_f32 v2, v68, v69, v2
    v_max3_f32 v1, v70, v71, v1
    v_max_f32 v1, v1, v2
    v_mov_b32 v2, v1
    s_nop 1
    v_permlane32_swap_b32 v1, v2
    s_nop 1
    v_max_f32 v1, v1, v2
    v_sub_f32 v88, 0, v1
    v_sub_f32 v89, 0, v1
    v_sub_f32 v90, 0, v1
    v_sub_f32 v91, 0, v1
    v_sub_f32 v92, 0, v1
    v_sub_f32 v93, 0, v1
    v_sub_f32 v94, 0, v1
    v_sub_f32 v95, 0, v1
    v_sub_f32 v96, 0, v1
    v_sub_f32 v97, 0, v1
    v_sub_f32 v98, 0, v1
    v_sub_f32 v99, 0, v1
    v_sub_f32 v100, 0, v1
    v_sub_f32 v101, 0, v1
    v_sub_f32 v102, 0, v1
    v_sub_f32 v103, 0, v1
    s_nop 1
    v_mfma_f32_32x32x16_bf16 v[40:55], v[8:11], v[4:7], v[88:103]
    s_nop 9
    .p2align 6
AL_27:
    s_waitcnt lgkmcnt(2)
    s_setprio 3
    v_mfma_f32_32x32x16_bf16 v[56:71], v[12:15], v[4:7], v[88:103]
    ds_read_b128 v[8:11], v107 offset:4096
    v_exp_f32 v40, v40
    v_exp_f32 v41, v41
    v_exp_f32 v42, v42
    v_exp_f32 v43, v43
    s_setprio 2
    v_smfmac_f32_32x32x32_bf16 v[72:87], v[28:31], v[32:39], v112
    s_mov_b64 exec, s[50:51]
    ds_read_b128 v[24:27], v108 offset:2048
    ds_read_b128 v[28:31], v108 offset:2560
    s_mov_b64 exec, -1
    v_exp_f32 v44, v44
    v_exp_f32 v45, v45
    v_exp_f32 v46, v46
    v_exp_f32 v47, v47
    v_exp_f32 v32, v48
    v_exp_f32 v33, v49
    s_waitcnt lgkmcnt(3)
    s_setprio 1
    v_smfmac_f32_32x32x32_bf16 v[72:87], v[16:19], v[40:47], v112
    v_exp_f32 v34, v50
    v_exp_f32 v35, v51
    v_exp_f32 v36, v52
    v_exp_f32 v37, v53
    v_exp_f32 v38, v54
    v_exp_f32 v39, v55
    s_waitcnt lgkmcnt(2)
    s_setprio 0
    v_mfma_f32_32x32x16_bf16 v[40:55], v[8:11], v[4:7], v[88:103]
    ds_read_b128 v[12:15], v107 offset:6144
    v_exp_f32 v56, v56
    v_exp_f32 v57, v57
    v_exp_f32 v58, v58
    v_exp_f32 v59, v59
    s_setprio 3
    v_smfmac_f32_32x32x32_bf16 v[72:87], v[20:23], v[32:39], v112
    s_mov_b64 exec, s[50:51]
    ds_read_b128 v[16:19], v108 offset:4096
    ds_read_b128 v[20:23], v108 offset:4608
    s_mov_b64 exec, -1
    v_exp_f32 v60, v60
    v_exp_f32 v61, v61
    v_exp_f32 v62, v62
    v_exp_f32 v63, v63
    v_exp_f32 v32, v64
    v_exp_f32 v33, v65
    s_waitcnt lgkmcnt(3)
    s_setprio 2
    v_smfmac_f32_32x32x32_bf16 v[72:87], v[24:27], v[56:63], v112
    v_exp_f32 v34, v66
    v_exp_f32 v35, v67
    v_exp_f32 v36, v68
    v_exp_f32 v37, v69
    v_exp_f32 v38, v70
    v_exp_f32 v39, v71
    s_waitcnt lgkmcnt(2)
    s_setprio 1
    v_mfma_f32_32x32x16_bf16 v[56:71], v[12:15], v[4:7], v[88:103]
    ds_read_b128 v[8:11], v107 offset:8192
    s_cmp_lt_u32 s65, 2
    s_cbranch_scc1 AV_31
    s_waitcnt vmcnt(0)
AV_31:
    s_waitcnt vmcnt(2)
    s_sub_u32 s76, s64, 1
    s_max_u32 s76, s76, 13
    v_mov_b32 v113, s64
    ds_write_b32 v104, v113
    s_cmp_lg_u32 s65, 3
    s_cbranch_scc1 AM_32
    buffer_store_dwordx4 v[116:119], v111, s[4:7], s73 offen sc1
AM_32:
    s_cmp_lg_u32 s65, 5
    s_cbranch_scc1 AM_33
    buffer_store_dword v120, v121, s[4:7], s59 offen sc1
AM_33:
    v_exp_f32 v40, v40
    v_exp_f32 v41, v41
    v_exp_f32 v42, v42
    v_exp_f32 v43, v43
    s_setprio 0
    v_smfmac_f32_32x32x32_bf16 v[72:87], v[28:31], v[32:39], v112
    s_mov_b64 exec, s[50:51]
    ds_read_b128 v[24:27], v108 offset:6144
    ds_read_b128 v[28:31], v108 offset:6656
    s_mov_b64 exec, -1
    v_exp_f32 v44, v44
    v_exp_f32 v45, v45
    v_exp_f32 v46, v46
    v_exp_f32 v47, v47
    v_exp_f32 v32, v48
    v_exp_f32 v33, v49
    s_waitcnt lgkmcnt(4)
    s_setprio 3
    v_smfmac_f32_32x32x32_bf16 v[72:87], v[16:19], v[40:47], v112
    v_exp_f32 v34, v50
    v_exp_f32 v35, v51
    v_exp_f32 v36, v52
    v_exp_f32 v37, v53
    v_exp_f32 v38, v54
    v_exp_f32 v39, v55
    s_waitcnt lgkmcnt(2)
    s_setprio 2
    v_mfma_f32_32x32x16_bf16 v[40:55], v[8:11], v[4:7], v[88:103]
    ds_read_b128 v[12:15], v107 offset:10240
    v_exp_f32 v56, v56
    v_exp_f32 v57, v57
    v_exp_f32 v58, v58
    v_exp_f32 v59, v59
    s_setprio 1
    v_smfmac_f32_32x32x32_bf16 v[72:87], v[20:23], v[32:39], v112
    s_mov_b64 exec, s[50:51]
    ds_read_b128 v[16:19], v108 offset:8192
    ds_read_b128 v[20:23], v108 offset:8704
    s_mov_b64 exec, -1
    v_exp_f32 v60, v60
    v_exp_f32 v61, v61
    v_exp_f32 v62, v62
    v_exp_f32 v63, v63
    v_exp_f32 v32, v64
    v_exp_f32 v33, v65
    s_waitcnt lgkmcnt(3)
    s_setprio 0
    v_smfmac_f32_32x32x32_bf16 v[72:87], v[24:27], v[56:63], v112
    v_exp_f32 v34, v66
    v_exp_f32 v35, v67
    v_exp_f32 v36, v68
    v_exp_f32 v37, v69
    v_exp_f32 v38, v70
    v_exp_f32 v39, v71
    s_waitcnt lgkmcnt(2)
    s_setprio 3
    v_mfma_f32_32x32x16_bf16 v[56:71], v[12:15], v[4:7], v[88:103]
    ds_read_b128 v[8:11], v107 offset:12288
    ds_read_b32 v113, v105
    v_exp_f32 v40, v40
    v_exp_f32 v41, v41
    v_exp_f32 v42, v42
    v_exp_f32 v43, v43
    s_setprio 2
    v_smfmac_f32_32x32x32_bf16 v[72:87], v[28:31], v[32:39], v112
    s_mov_b64 exec, s[50:51]
    ds_read_b128 v[24:27], v108 offset:10240
    ds_read_b128 v[28:31], v108 offset:10752
    s_mov_b64 exec, -1
    v_exp_f32 v44, v44
    v_exp_f32 v45, v45
    v_exp_f32 v46, v46
    v_exp_f32 v47, v47
    v_exp_f32 v32, v48
    v_exp_f32 v33, v49
    s_waitcnt lgkmcnt(4)
    s_setprio 1
    v_smfmac_f32_32x32x32_bf16 v[72:87], v[16:19], v[40:47], v112
    v_exp_f32 v34, v50
    v_exp_f32 v35, v51
    v_exp_f32 v36, v52
    v_exp_f32 v37, v53
    v_exp_f32 v38, v54
    v_exp_f32 v39, v55
    s_waitcnt lgkmcnt(2)
    v_cmp_gt_u32 vcc, s76, v113
    s_cbranch_vccnz AS_28
AB_29:
    s_setprio 0
    v_mfma_f32_32x32x16_bf16 v[40:55], v[8:11], v[4:7], v[88:103]
    ds_read_b128 v[12:15], v107 offset:14336
    v_exp_f32 v56, v56
    v_exp_f32 v57, v57
    v_exp_f32 v58, v58
    v_exp_f32 v59, v59
    s_setprio 3
    v_smfmac_f32_32x32x32_bf16 v[72:87], v[20:23], v[32:39], v112
    s_mov_b64 exec, s[50:51]
    ds_read_b128 v[16:19], v108 offset:12288
    ds_read_b128 v[20:23], v108 offset:12800
    s_mov_b64 exec, -1
    v_exp_f32 v60, v60
    v_exp_f32 v61, v61
    v_exp_f32 v62, v62
    v_exp_f32 v63, v63
    v_exp_f32 v32, v64
    v_exp_f32 v33, v65
    s_waitcnt lgkmcnt(3)
    s_setprio 2
    v_smfmac_f32_32x32x32_bf16 v[72:87], v[24:27], v[56:63], v112
    s_lshr_b32 s52, 0x1d, s65
    s_and_b32 s52, s52, 1
    s_cbranch_scc0 AN_30
    s_lshl_b32 s52, s62, 14
    s_mov_b32 m0, s69
    s_add_u32 s52, s52, s67
    buffer_load_dwordx4 v111, s[4:7], s52 offen sc1 lds
    buffer_load_dwordx4 v111, s[4:7], s52 offen offset:1024 sc1 lds
    s_add_u32 s62, s62, 1
    s_and_b32 s62, s62, 7
    s_add_u32 s69, s69, 16384
    s_cmp_ge_u32 s69, 81920
    s_cselect_b32 s52, 81920, 0
    s_sub_u32 s69, s69, s52
AN_30:
    v_exp_f32 v34, v66
    v_exp_f32 v35, v67
    v_exp_f32 v36, v68
    v_exp_f32 v37, v69
    v_exp_f32 v38, v70
    v_exp_f32 v39, v71
    s_waitcnt lgkmcnt(2)
    s_setprio 1
    v_mfma_f32_32x32x16_bf16 v[56:71], v[12:15], v[4:7], v[88:103]
    ds_read_b128 v[8:11], v109 offset:0
    v_exp_f32 v40, v40
    v_exp_f32 v41, v41
    v_exp_f32 v42, v42
    v_exp_f32 v43, v43
    s_setprio 0
    v_smfmac_f32_32x32x32_bf16 v[72:87], v[28:31], v[32:39], v112
    s_mov_b64 exec, s[50:51]
    ds_read_b128 v[24:27], v108 offset:14336
    ds_read_b128 v[28:31], v108 offset:14848
    s_mov_b64 exec, -1
    v_exp_f32 v44, v44
    v_exp_f32 v45, v45
    v_exp_f32 v46, v46
    v_exp_f32 v47, v47
    v_exp_f32 v32, v48
    v_exp_f32 v33, v49
    s_waitcnt lgkmcnt(3)
    s_setprio 3
    v_smfmac_f32_32x32x32_bf16 v[72:87], v[16:19], v[40:47], v112
    v_exp_f32 v34, v50
    v_exp_f32 v35, v51
    v_exp_f32 v36, v52
    v_exp_f32 v37, v53
    v_exp_f32 v38, v54
    v_exp_f32 v39, v55
    s_waitcnt lgkmcnt(2)
    s_setprio 2
    v_mfma_f32_32x32x16_bf16 v[40:55], v[8:11], v[4:7], v[88:103]
    ds_read_b128 v[12:15], v109 offset:2048
    v_exp_f32 v56, v56
    v_exp_f32 v57, v57
    v_exp_f32 v58, v58
    v_exp_f32 v59, v59
    s_setprio 1
    v_smfmac_f32_32x32x32_bf16 v[72:87], v[20:23], v[32:39], v112
    s_mov_b64 exec, s[50:51]
    ds_read_b128 v[16:19], v110 offset:0
    ds_read_b128 v[20:23], v110 offset:512
    s_mov_b64 exec, -1
    v_exp_f32 v60, v60
    v_exp_f32 v61, v61
    v_exp_f32 v62, v62
    v_exp_f32 v63, v63
    v_exp_f32 v32, v64
    v_exp_f32 v33, v65
    s_waitcnt lgkmcnt(3)
    s_setprio 0
    v_smfmac_f32_32x32x32_bf16 v[72:87], v[24:27], v[56:63], v112
    v_exp_f32 v34, v66
    v_exp_f32 v35, v67
    v_exp_f32 v36, v68
    v_exp_f32 v37, v69
    v_exp_f32 v38, v70
    v_exp_f32 v39, v71
    v_mov_b32 v107, v109
    v_mov_b32 v108, v110
    s_add_u32 s53, s71, 16384
    s_cmp_eq_u32 s53, 81920
    s_cselect_b32 s53, 0, s53
    s_sub_u32 s52, s53, s71
    s_mov_b32 s71, s53
    v_add_u32 v109, s52, v109
    v_add_u32 v110, s52, v110
    s_add_u32 s64, s64, 1
    s_add_u32 s65, s65, 1
    s_cmp_lt_u32 s65, 8
    s_cbranch_scc1 AL_27
    v_smfmac_f32_32x32x32_bf16 v[72:87], v[28:31], v[32:39], v112
    s_nop 11
    v_mov_b32 v1, v80
    v_mov_b32 v2, 0x5d800000
    s_movk_i32 s52, 0x207
    v_permlane32_swap_b32 v80, v1
    s_nop 1
    v_cmp_nle_f32 vcc, v80, v2
    v_cmp_class_f32 s[54:55], v72, s52
    s_or_b64 vcc, vcc, s[54:55]
    v_cmp_class_f32 s[54:55], v73, s52
    s_or_b64 vcc, vcc, s[54:55]
    v_cmp_class_f32 s[54:55], v74, s52
    s_or_b64 vcc, vcc, s[54:55]
    v_cmp_class_f32 s[54:55], v75, s52
    s_or_b64 vcc, vcc, s[54:55]
    v_cmp_class_f32 s[54:55], v76, s52
    s_or_b64 vcc, vcc, s[54:55]
    v_cmp_class_f32 s[54:55], v77, s52
    s_or_b64 vcc, vcc, s[54:55]
    v_cmp_class_f32 s[54:55], v78, s52
    s_or_b64 vcc, vcc, s[54:55]
    v_cmp_class_f32 s[54:55], v79, s52
    s_or_b64 vcc, vcc, s[54:55]
    s_cbranch_vccnz AR_35
AF_34:
    v_rcp_f32 v1, v80
    s_nop 0
    v_mul_f32 v1, v1, v114
    v_mul_f32 v72, v72, v1
    v_mul_f32 v73, v73, v1
    v_mul_f32 v74, v74, v1
    v_mul_f32 v75, v75, v1
    v_mul_f32 v76, v76, v1
    v_mul_f32 v77, v77, v1
    v_mul_f32 v78, v78, v1
    v_mul_f32 v79, v79, v1
    v_cvt_pk_bf16_f32 v4, v72, v73
    v_cvt_pk_bf16_f32 v5, v74, v75
    v_cvt_pk_bf16_f32 v6, v76, v77
    v_cvt_pk_bf16_f32 v7, v78, v79
    v_min_u32 v4, -2, v4
    v_min_u32 v5, -2, v5
    v_min_u32 v6, -2, v6
    v_min_u32 v7, -2, v7
    buffer_store_dwordx4 v[4:7], v111, s[4:7], s73 offen sc1
    s_endpgm
AS_28:
W_36:
    ds_read_b32 v113, v105
    s_waitcnt lgkmcnt(0)
    v_cmp_gt_u32 vcc, s76, v113
    s_cbranch_vccz W_37
    s_sleep 2
    s_sub_u32 s48, s48, 1
    s_cbranch_scc0 W_36
    s_mov_b32 s48, 0
W_37:
    s_branch AB_29
AR_35:
    s_waitcnt lgkmcnt(0)
    v_mov_b32 v107, 0xff800000
    s_mov_b32 s65, 0
    s_mov_b32 s52, s63
AR_38:
    buffer_load_dwordx4 v[8:11], v111, s[4:7], s52 offen sc1
    s_waitcnt vmcnt(0)
    v_mfma_f32_32x32x16_bf16 v[40:55], v[8:11], v[4:7], 0
    s_nop 15
    v_max3_f32 v107, v40, v41, v107
    v_max3_f32 v107, v42, v43, v107
    v_max3_f32 v107, v44, v45, v107
    v_max3_f32 v107, v46, v47, v107
    v_max3_f32 v107, v48, v49, v107
    v_max3_f32 v107, v50, v51, v107
    v_max3_f32 v107, v52, v53, v107
    v_max3_f32 v107, v54, v55, v107
    s_add_u32 s52, s52, 2048
    s_add_u32 s65, s65, 1
    s_cmp_lt_u32 s65, 64
    s_cbranch_scc1 AR_38
    v_mov_b32 v1, v107
    s_nop 1
    v_permlane32_swap_b32 v107, v1
    s_nop 1
    v_max_f32 v1, v1, v107
    v_sub_f32 v88, 0, v1
    v_mov_b32 v72, 0
    v_sub_f32 v89, 0, v1
    v_mov_b32 v73, 0
    v_sub_f32 v90, 0, v1
    v_mov_b32 v74, 0
    v_sub_f32 v91, 0, v1
    v_mov_b32 v75, 0
    v_sub_f32 v92, 0, v1
    v_mov_b32 v76, 0
    v_sub_f32 v93, 0, v1
    v_mov_b32 v77, 0
    v_sub_f32 v94, 0, v1
    v_mov_b32 v78, 0
    v_sub_f32 v95, 0, v1
    v_mov_b32 v79, 0
    v_sub_f32 v96, 0, v1
    v_mov_b32 v80, 0
    v_sub_f32 v97, 0, v1
    v_mov_b32 v81, 0
    v_sub_f32 v98, 0, v1
    v_mov_b32 v82, 0
    v_sub_f32 v99, 0, v1
    v_mov_b32 v83, 0
    v_sub_f32 v100, 0, v1
    v_mov_b32 v84, 0
    v_sub_f32 v101, 0, v1
    v_mov_b32 v85, 0
    v_sub_f32 v102, 0, v1
    v_mov_b32 v86, 0
    v_sub_f32 v103, 0, v1
    v_mov_b32 v87, 0
    v_and_b32 v1, 15, v0
    v_lshlrev_b32 v1, 4, v1
    v_lshrrev_b32 v2, 5, v0
    v_lshl_add_u32 v108, v2, 8, v1
    s_mov_b32 s65, 0
    s_mov_b32 s52, s63
AR_39:
    buffer_load_dwordx4 v[8:11], v111, s[4:7], s52 offen sc1
    s_mov_b64 exec, s[50:51]
    buffer_load_dwordx4 v[16:19], v108, s[4:7], s52 offen offset:1024 sc1
    buffer_load_dwordx4 v[20:23], v108, s[4:7], s52 offen offset:1536 sc1
    s_mov_b64 exec, -1
    s_waitcnt vmcnt(0)
    v_mfma_f32_32x32x16_bf16 v[40:55], v[8:11], v[4:7], v[88:103]
    s_nop 15
    v_exp_f32 v40, v40
    v_exp_f32 v41, v41
    v_exp_f32 v42, v42
    v_exp_f32 v43, v43
    v_exp_f32 v44, v44
    v_exp_f32 v45, v45
    v_exp_f32 v46, v46
    v_exp_f32 v47, v47
    v_exp_f32 v48, v48
    v_exp_f32 v49, v49
    v_exp_f32 v50, v50
    v_exp_f32 v51, v51
    v_exp_f32 v52, v52
    v_exp_f32 v53, v53
    v_exp_f32 v54, v54
    v_exp_f32 v55, v55
    s_nop 1
    v_smfmac_f32_32x32x32_bf16 v[72:87], v[16:19], v[40:47], v112
    v_smfmac_f32_32x32x32_bf16 v[72:87], v[20:23], v[48:55], v112
    s_add_u32 s52, s52, 2048
    s_add_u32 s65, s65, 1
    s_cmp_lt_u32 s65, 64
    s_cbranch_scc1 AR_39
    s_nop 15
    v_mov_b32 v1, v80
    s_nop 1
    v_permlane32_swap_b32 v80, v1
    s_nop 1
    s_branch AF_34
M_g:
    s_cmp_lg_u32 s3, 8
    s_cbranch_scc1 P_40
    v_lshlrev_b32 v2, 2, v0
    v_add_u32 v2, 163776, v2
    v_mov_b32 v3, 0
    ds_write_b32 v2, v3
P_40:
    s_waitcnt lgkmcnt(0)
    s_add_u32 s52, s38, 13651968
    s_addc_u32 s53, s39, 0
    s_load_dword s49, s[52:53], 0
    s_mov_b32 s8, s16
    s_mov_b32 s9, s17
    s_mov_b32 s10, 2097152
    s_mov_b32 s11, 0x00020000
    s_mov_b32 s12, s32
    s_mov_b32 s13, s33
    s_mov_b32 s14, 1024
    s_mov_b32 s15, 0x00020000
    s_sub_u32 s54, s3, 8
    s_and_b32 s79, s2, 7
    s_lshl_b32 s79, s79, 5
    s_lshr_b32 s55, s2, 3
    s_add_u32 s79, s79, s55
    s_lshl_b32 s55, s79, 3
    s_lshl1_add_u32 s55, s54, s55
    s_lshl_b32 s56, s55, 10
    v_lshlrev_b32 v1, 4, v0
    buffer_load_dwordx4 v[152:155], v1, s[8:11], s56 offen
    buffer_load_dwordx4 v[156:159], v1, s[8:11], s56 offen offset:1024
    buffer_load_dwordx4 v[160:163], v1, s[12:15], 0 offen
    s_lshl_b32 s52, s3, 2
    s_add_u32 s52, s52, 163776
    v_mov_b32 v14, 262144
    v_mov_b32 v15, s52
    v_cmp_eq_u32 vcc, 0, v0
    s_nop 1
    v_cndmask_b32 v14, v14, v15, vcc
    v_and_b32 v15, 3, v0
    v_lshlrev_b32 v15, 2, v15
    v_add_u32 v15, 163808, v15
    s_mov_b32 s4, s38
    s_mov_b32 s5, s39
    s_mov_b32 s6, 16777216
    s_mov_b32 s7, 0x00020000
    s_waitcnt lgkmcnt(0)
    s_add_u32 s49, s49, 0x9E3779B9
    s_barrier
    s_cmp_lg_u32 s54, 1
    s_cbranch_scc1 XA_41
    s_getreg_b32 s52, hwreg(HW_REG_XCC_ID, 0, 4)
    s_add_u32 s52, s52, s49
    s_lshl_b32 s53, s79, 7
    s_add_u32 s53, s53, 14024704
    v_mov_b32 v2, s52
    v_cmp_eq_u32 vcc, 0, v0
    v_mov_b32 v3, 0x7ffffff0
    s_nop 0
    v_cndmask_b32 v3, v3, 0, vcc
    s_waitcnt vmcnt(63)
    buffer_store_dword v2, v3, s[4:7], s53 offen sc1
XA_41:
    s_cmp_eq_u32 s54, 1
    s_cbranch_scc1 LN_w1
    s_waitcnt vmcnt(0)
LN_w1:
    s_waitcnt vmcnt(1)
    v_lshlrev_b32 v88, 16, v152
    v_and_b32 v89, 0xffff0000, v152
    v_lshlrev_b32 v90, 16, v153
    v_and_b32 v91, 0xffff0000, v153
    v_lshlrev_b32 v92, 16, v154
    v_and_b32 v93, 0xffff0000, v154
    v_lshlrev_b32 v94, 16, v155
    v_and_b32 v95, 0xffff0000, v155
    v_lshlrev_b32 v96, 16, v156
    v_and_b32 v97, 0xffff0000, v156
    v_lshlrev_b32 v98, 16, v157
    v_and_b32 v99, 0xffff0000, v157
    v_lshlrev_b32 v100, 16, v158
    v_and_b32 v101, 0xffff0000, v158
    v_lshlrev_b32 v102, 16, v159
    v_and_b32 v103, 0xffff0000, v159
    v_lshlrev_b32 v104, 16, v160
    v_and_b32 v105, 0xffff0000, v160
    v_lshlrev_b32 v106, 16, v161
    v_and_b32 v107, 0xffff0000, v161
    v_lshlrev_b32 v108, 16, v162
    v_and_b32 v109, 0xffff0000, v162
    v_lshlrev_b32 v110, 16, v163
    v_and_b32 v111, 0xffff0000, v163
    v_add_f32 v112, v88, v89
    v_add_f32 v113, v96, v97
    v_mul_f32 v114, v88, v104
    v_mul_f32 v115, v96, v104
    v_add_f32 v112, v112, v90
    v_add_f32 v113, v113, v98
    v_add_f32 v112, v112, v91
    v_add_f32 v113, v113, v99
    v_add_f32 v112, v112, v92
    v_add_f32 v113, v113, v100
    v_add_f32 v112, v112, v93
    v_add_f32 v113, v113, v101
    v_add_f32 v112, v112, v94
    v_add_f32 v113, v113, v102
    v_add_f32 v112, v112, v95
    v_add_f32 v113, v113, v103
    v_fmac_f32 v114, v89, v105
    v_fmac_f32 v115, v97, v105
    v_fmac_f32 v114, v90, v106
    v_fmac_f32 v115, v98, v106
    v_fmac_f32 v114, v91, v107
    v_fmac_f32 v115, v99, v107
    v_fmac_f32 v114, v92, v108
    v_fmac_f32 v115, v100, v108
    v_fmac_f32 v114, v93, v109
    v_fmac_f32 v115, v101, v109
    v_fmac_f32 v114, v94, v110
    v_fmac_f32 v115, v102, v110
    v_fmac_f32 v114, v95, v111
    v_fmac_f32 v115, v103, v111
    s_nop 1
    v_add_f32_dpp v112, v112, v112 row_ror:1 row_mask:0xf bank_mask:0xf
    v_add_f32_dpp v113, v113, v113 row_ror:1 row_mask:0xf bank_mask:0xf
    v_add_f32_dpp v114, v114, v114 row_ror:1 row_mask:0xf bank_mask:0xf
    v_add_f32_dpp v115, v115, v115 row_ror:1 row_mask:0xf bank_mask:0xf
    v_add_f32_dpp v112, v112, v112 row_ror:2 row_mask:0xf bank_mask:0xf
    v_add_f32_dpp v113, v113, v113 row_ror:2 row_mask:0xf bank_mask:0xf
    v_add_f32_dpp v114, v114, v114 row_ror:2 row_mask:0xf bank_mask:0xf
    v_add_f32_dpp v115, v115, v115 row_ror:2 row_mask:0xf bank_mask:0xf
    v_add_f32_dpp v112, v112, v112 row_ror:4 row_mask:0xf bank_mask:0xf
    v_add_f32_dpp v113, v113, v113 row_ror:4 row_mask:0xf bank_mask:0xf
    v_add_f32_dpp v114, v114, v114 row_ror:4 row_mask:0xf bank_mask:0xf
    v_add_f32_dpp v115, v115, v115 row_ror:4 row_mask:0xf bank_mask:0xf
    v_add_f32_dpp v112, v112, v112 row_ror:8 row_mask:0xf bank_mask:0xf
    v_add_f32_dpp v113, v113, v113 row_ror:8 row_mask:0xf bank_mask:0xf
    v_add_f32_dpp v114, v114, v114 row_ror:8 row_mask:0xf bank_mask:0xf
    v_add_f32_dpp v115, v115, v115 row_ror:8 row_mask:0xf bank_mask:0xf
    v_mov_b32 v116, v112
    v_mov_b32 v117, v113
    v_mov_b32 v118, v114
    v_mov_b32 v119, v115
    s_nop 1
    v_permlane16_swap_b32 v112, v116
    v_permlane16_swap_b32 v113, v117
    v_permlane16_swap_b32 v114, v118
    v_permlane16_swap_b32 v115, v119
    s_nop 1
    v_add_f32 v112, v112, v116
    v_add_f32 v113, v113, v117
    v_add_f32 v114, v114, v118
    v_add_f32 v115, v115, v119
    s_nop 1
    v_mov_b32 v116, v112
    v_mov_b32 v117, v113
    v_mov_b32 v118, v114
    v_mov_b32 v119, v115
    s_nop 1
    v_permlane32_swap_b32 v112, v116
    v_permlane32_swap_b32 v113, v117
    v_permlane32_swap_b32 v114, v118
    v_permlane32_swap_b32 v115, v119
    s_nop 1
    v_add_f32 v112, v112, v116
    v_add_f32 v113, v113, v117
    v_add_f32 v114, v114, v118
    v_add_f32 v115, v115, v119
    s_nop 1
    v_mul_f32 v112, 0x3b000000, v112
    v_mul_f32 v113, 0x3b000000, v113
    v_sub_f32 v88, v88, v112
    v_sub_f32 v96, v96, v113
    v_sub_f32 v89, v89, v112
    v_sub_f32 v97, v97, v113
    v_sub_f32 v90, v90, v112
    v_sub_f32 v98, v98, v113
    v_sub_f32 v91, v91, v112
    v_sub_f32 v99, v99, v113
    v_sub_f32 v92, v92, v112
    v_sub_f32 v100, v100, v113
    v_sub_f32 v93, v93, v112
    v_sub_f32 v101, v101, v113
    v_sub_f32 v94, v94, v112
    v_sub_f32 v102, v102, v113
    v_sub_f32 v95, v95, v112
    v_sub_f32 v103, v103, v113
    v_mul_f32 v112, v88, v88
    v_mul_f32 v113, v96, v96
    v_fmac_f32 v112, v89, v89
    v_fmac_f32 v113, v97, v97
    v_fmac_f32 v112, v90, v90
    v_fmac_f32 v113, v98, v98
    v_fmac_f32 v112, v91, v91
    v_fmac_f32 v113, v99, v99
    v_fmac_f32 v112, v92, v92
    v_fmac_f32 v113, v100, v100
    v_fmac_f32 v112, v93, v93
    v_fmac_f32 v113, v101, v101
    v_fmac_f32 v112, v94, v94
    v_fmac_f32 v113, v102, v102
    v_fmac_f32 v112, v95, v95
    v_fmac_f32 v113, v103, v103
    s_nop 1
    v_add_f32_dpp v112, v112, v112 row_ror:1 row_mask:0xf bank_mask:0xf
    v_add_f32_dpp v113, v113, v113 row_ror:1 row_mask:0xf bank_mask:0xf
    s_nop 1
    v_add_f32_dpp v112, v112, v112 row_ror:2 row_mask:0xf bank_mask:0xf
    v_add_f32_dpp v113, v113, v113 row_ror:2 row_mask:0xf bank_mask:0xf
    s_nop 1
    v_add_f32_dpp v112, v112, v112 row_ror:4 row_mask:0xf bank_mask:0xf
    v_add_f32_dpp v113, v113, v113 row_ror:4 row_mask:0xf bank_mask:0xf
    s_nop 1
    v_add_f32_dpp v112, v112, v112 row_ror:8 row_mask:0xf bank_mask:0xf
    v_add_f32_dpp v113, v113, v113 row_ror:8 row_mask:0xf bank_mask:0xf
    s_nop 1
    v_mov_b32 v116, v112
    v_mov_b32 v117, v113
    s_nop 1
    v_permlane16_swap_b32 v112, v116
    v_permlane16_swap_b32 v113, v117
    s_nop 1
    v_add_f32 v112, v112, v116
    v_add_f32 v113, v113, v117
    s_nop 1
    v_mov_b32 v116, v112
    v_mov_b32 v117, v113
    s_nop 1
    v_permlane32_swap_b32 v112, v116
    v_permlane32_swap_b32 v113, v117
    s_nop 1
    v_add_f32 v112, v112, v116
    v_add_f32 v113, v113, v117
    s_nop 1
    v_mov_b32 v116, 0x3727c5ac
    v_fmac_f32 v116, 0x3b000000, v112
    v_mov_b32 v117, 0x3727c5ac
    v_fmac_f32 v117, 0x3b000000, v113
    v_rsq_f32 v112, v116
    v_rsq_f32 v113, v117
    v_cmp_eq_u32 vcc, 0, v0
    v_mul_f32 v114, 0xbfb8aa3b, v114
    v_mul_f32 v115, 0xbfb8aa3b, v115
    v_cndmask_b32 v114, v115, v114, vcc
    v_exp_f32 v114, v114
    v_mul_f32 v88, v88, v112
    v_mul_f32 v96, v96, v113
    v_mul_f32 v89, v89, v112
    v_mul_f32 v97, v97, v113
    v_mul_f32 v90, v90, v112
    v_mul_f32 v98, v98, v113
    v_mul_f32 v91, v91, v112
    v_mul_f32 v99, v99, v113
    v_mul_f32 v92, v92, v112
    v_mul_f32 v100, v100, v113
    v_mul_f32 v93, v93, v112
    v_mul_f32 v101, v101, v113
    v_mul_f32 v94, v94, v112
    v_mul_f32 v102, v102, v113
    v_mul_f32 v95, v95, v112
    v_mul_f32 v103, v103, v113
    v_add_f32 v114, 1.0, v114
    v_rcp_f32 v114, v114
    v_cvt_pk_bf16_f32 v152, v88, v89
    v_cvt_pk_bf16_f32 v156, v96, v97
    v_cvt_pk_bf16_f32 v153, v90, v91
    v_cvt_pk_bf16_f32 v157, v98, v99
    v_cvt_pk_bf16_f32 v154, v92, v93
    v_cvt_pk_bf16_f32 v158, v100, v101
    v_cvt_pk_bf16_f32 v155, v94, v95
    v_cvt_pk_bf16_f32 v159, v102, v103
    s_mul_i32 s56, s54, 2176
    s_add_u32 s56, s56, 131072
    v_lshl_add_u32 v1, v0, 4, s56
    ds_write_b128 v1, v[152:155]
    ds_write_b128 v1, v[156:159] offset:1088
    v_lshlrev_b32 v2, 2, v0
    v_cmp_gt_u32 vcc, 2, v0
    v_mov_b32 v3, 0x7ffffff0
    s_lshl_b32 s56, s55, 2
    v_cndmask_b32 v120, v3, v2, vcc
    s_add_u32 s59, s56, 12582912
    v_mov_b32 v3, 1
    ds_write_b32 v14, v3
    v_bfe_u32 v1, v0, 2, 2
    v_mul_u32_u24 v1, 1088, v1
    v_lshrrev_b32 v2, 4, v0
    v_lshl_add_u32 v1, v2, 5, v1
    v_and_b32 v2, 3, v0
    v_lshl_add_u32 v1, v2, 3, v1
    s_lshl_b32 s56, s54, 8
    s_add_u32 s56, s56, 131072
    v_add_u32 v1, s56, v1
W_42:
    ds_read_b32 v3, v15
    s_waitcnt lgkmcnt(0)
    v_cmp_gt_u32 vcc, 1, v3
    s_cbranch_vccz W_43
    s_sub_u32 s48, s48, 1
    s_cbranch_scc0 W_42
    s_mov_b32 s48, 0
W_43:
    ds_read_b64_tr_b16 v[152:153], v1
    ds_read_b64_tr_b16 v[154:155], v1 offset:4352
    ds_read_b64_tr_b16 v[156:157], v1 offset:128
    ds_read_b64_tr_b16 v[158:159], v1 offset:4480
    v_lshrrev_b32 v1, 5, v0
    v_lshlrev_b32 v1, 17, v1
    v_and_b32 v2, 31, v0
    v_lshl_add_u32 v1, v2, 4, v1
    s_lshl_b32 s56, s54, 19
    s_lshr_b32 s57, s79, 1
    s_lshl_b32 s57, s57, 10
    s_add_u32 s56, s56, s57
    s_and_b32 s57, s79, 1
    s_lshl_b32 s57, s57, 9
    s_add_u32 s56, s56, s57
    s_add_u32 s56, s56, 6291456
    s_add_u32 s57, s56, 262144
    v_and_b32 v2, 3, v0
    v_lshlrev_b32 v2, 2, v2
    v_add_u32 v2, 163792, v2
W_44:
    ds_read_b32 v3, v2
    s_waitcnt lgkmcnt(0)
    v_cmp_gt_u32 vcc, 2, v3
    s_cbranch_vccz W_45
    s_sleep 2
    s_sub_u32 s48, s48, 1
    s_cbranch_scc0 W_44
    s_mov_b32 s48, 0
W_45:
    s_waitcnt lgkmcnt(0)
    buffer_store_dword v114, v120, s[4:7], s59 offen sc1
    buffer_store_dwordx4 v[152:155], v1, s[4:7], s56 offen sc1
    buffer_store_dwordx4 v[156:159], v1, s[4:7], s57 offen sc1
    s_waitcnt vmcnt(0)
    v_mov_b32 v3, 2
    ds_write_b32 v14, v3
    s_cmp_lg_u32 s54, 0
    s_cbranch_scc1 LF_46
    s_lshl_b32 s56, s79, 7
    s_add_u32 s56, s56, 13697024
W_47:
    ds_read_b32 v3, v15
    s_waitcnt lgkmcnt(0)
    v_cmp_gt_u32 vcc, 2, v3
    s_cbranch_vccz W_48
    s_sub_u32 s48, s48, 1
    s_cbranch_scc0 W_47
    s_mov_b32 s48, 0
W_48:
    v_mov_b32 v2, s49
    v_cmp_eq_u32 vcc, 0, v0
    v_mov_b32 v3, 0x7ffffff0
    s_nop 0
    v_cndmask_b32 v3, v3, 0, vcc
    s_waitcnt vmcnt(0)
    buffer_store_dword v2, v3, s[4:7], s56 offen sc1
LF_46:
    s_cmp_lg_u32 s54, 1
    s_cbranch_scc1 XD_49
    s_and_b32 s52, s79, 0xe0
    s_lshl_b32 s52, s52, 7
    s_add_u32 s52, s52, 14024704
    v_and_b32 v1, 31, v0
    v_lshl_add_u32 v1, v1, 7, s52
    s_getreg_b32 s53, hwreg(HW_REG_XCC_ID, 0, 4)
XD_50:
    buffer_load_dword v2, v1, s[4:7], 0 offen sc1
    s_waitcnt vmcnt(0)
    v_subrev_u32 v2, s49, v2
    v_cmp_lt_u32 vcc, 15, v2
    s_cbranch_vccz XD_51
    s_sleep 4
    s_sub_u32 s48, s48, 1
    s_cbranch_scc0 XD_50
    s_mov_b32 s48, 0
XD_51:
    v_cmp_ne_u32 vcc, s53, v2
    s_cmp_eq_u64 vcc, 0
    s_cselect_b32 s52, 1, 2
    v_mov_b32 v1, 163824
    v_mov_b32 v2, s52
    ds_write_b32 v1, v2
XD_49:
    v_and_b32 v2, 3, v0
    v_lshlrev_b32 v2, 2, v2
    v_add_u32 v2, 163792, v2
W_52:
    ds_read_b32 v3, v2
    s_waitcnt lgkmcnt(0)
    v_cmp_gt_u32 vcc, 4, v3
    s_cbranch_vccz W_53
    s_sleep 2
    s_sub_u32 s48, s48, 1
    s_cbranch_scc0 W_52
    s_mov_b32 s48, 0
W_53:
    s_and_b32 s52, s2, 7
    s_lshl2_add_u32 s52, s52, s54
    s_lshl_b32 s52, s52, 5
    s_lshr_b32 s53, s2, 3
    s_add_u32 s52, s52, s53
    s_lshl_b32 s56, s52, 11
    s_lshl_b32 s57, s52, 12
    s_add_u32 s57, s57, 2097152
    v_lshlrev_b32 v3, 4, v0
    buffer_load_dwordx4 v[128:131], v3, s[4:7], s56 offen sc1
    buffer_load_dwordx4 v[132:135], v3, s[4:7], s56 offen offset:1024 sc1
    s_cmp_ge_u32 s53, 4
    s_cbranch_scc1 QL_54
    buffer_load_dwordx4 v[136:139], v3, s[4:7], s57 offen offset:0 sc1
    buffer_load_dwordx4 v[140:143], v3, s[4:7], s57 offen offset:1024 sc1
    buffer_load_dwordx4 v[144:147], v3, s[4:7], s57 offen offset:2048 sc1
    buffer_load_dwordx4 v[148:151], v3, s[4:7], s57 offen offset:3072 sc1
QL_54:
    s_sub_u32 s54, s3, 8
    s_lshr_b32 s82, s2, 3
    s_and_b32 s52, s2, 7
    s_bfe_u32 s53, s2, 0x20003
    s_lshl2_add_u32 s80, s52, s53
    s_lshr_b32 s81, s2, 5
    s_mov_b32 s12, s34
    s_mov_b32 s13, s35
    s_mov_b32 s14, 2097152
    s_mov_b32 s15, 0x00020000
    v_lshrrev_b32 v1, 3, v0
    v_and_b32 v2, 7, v0
    v_bfe_u32 v3, v0, 4, 1
    v_lshlrev_b32 v3, 2, v3
    v_xor_b32 v2, v2, v3
    v_mul_u32_u24 v4, 4096, v1
    v_lshl_add_u32 v4, v2, 4, v4
    v_add_u32 v164, 31744, v4
    v_lshlrev_b32 v7, 4, v0
    v_bfe_u32 v1, v0, 2, 2
    v_lshrrev_b32 v2, 5, v0
    v_lshl_add_u32 v3, v2, 2, v1
    v_lshlrev_b32 v3, 7, v3
    v_lshrrev_b32 v1, 1, v1
    s_bfe_u32 s52, s54, 65536
    v_xor_b32 v1, s52, v1
    v_lshl_add_u32 v3, v1, 6, v3
    v_bfe_u32 v1, v0, 4, 1
    v_lshl_add_u32 v3, v1, 5, v3
    v_and_b32 v1, 3, v0
    v_lshl_add_u32 v3, v1, 3, v3
    s_mul_i32 s58, s54, 18432
    s_add_u32 s58, s58, 81920
    v_add_u32 v5, s58, v3
    v_xor_b32 v6, 64, v5
    s_lshr_b32 s52, s82, 2
    s_mul_i32 s74, s52, 4
    s_and_b32 s52, s82, 3
    s_mul_i32 s52, s52, 1
    s_add_u32 s74, s74, s52
    s_cmp_ge_u32 s74, 28
    s_cselect_b32 s52, 28, 0
    s_sub_u32 s74, s74, s52
    s_mul_i32 s76, s54, 1835008
    s_lshl_b32 s52, s80, 7
    s_add_u32 s76, s76, s52
    s_lshr_b32 s52, s54, 1
    s_lshl1_add_u32 s52, s81, s52
    s_xor_b32 s53, s52, 1
    s_mul_i32 s77, s52, 114688
    s_mul_i32 s78, s53, 114688
    s_mul_i32 s53, s54, 28672
    s_add_u32 s53, s53, 8388608
    s_add_u32 s77, s77, s53
    s_add_u32 s78, s78, s53
    s_min_u32 s53, s77, s78
    s_sub_u32 s52, s77, s53
    v_add_u32 v162, s52, v7
    s_sub_u32 s52, s78, s53
    v_add_u32 v163, s52, v7
    s_mov_b32 s77, s53
    s_add_u32 s78, s77, 28672
    s_lshl_b32 s75, s74, 10
    s_add_u32 s75, s75, s77
    s_add_u32 s72, s76, 1835008
    s_mul_i32 s74, s74, 65536
    s_add_u32 s74, s74, s76
    s_and_b32 s52, s54, 1
    s_lshl1_add_u32 s83, s80, s52
    v_lshrrev_b32 v1, 3, v0
    v_and_b32 v2, 7, v0
    v_bfe_u32 v3, v0, 4, 1
    v_lshlrev_b32 v3, 2, v3
    v_xor_b32 v2, v2, v3
    v_mul_u32_u24 v165, 1024, v1
    v_lshl_add_u32 v165, v2, 4, v165
    v_add_u32 v166, 7168, v165
    s_mov_b32 s67, 0
    s_lshl_b32 s66, s54, 17
    s_lshl_b32 s52, s81, 7
    s_add_u32 s66, s66, s52
    s_lshl_b32 s69, s80, 16
    s_lshl_b32 s53, s54, 13
    s_add_u32 s69, s69, s53
    s_add_u32 s69, s69, 10485760
    s_add_u32 s70, s69, 4096
    s_and_b32 s52, s54, 1
    s_lshl_b32 s52, s52, 15
    v_add_u32 v8, s52, v7
    v_xor_b32 v167, 32768, v8
    s_lshr_b32 s52, s54, 1
    s_xor_b32 s52, s52, s54
    s_and_b32 s52, s52, 1
    s_lshl_b32 s52, s52, 6
    v_xor_b32 v152, s52, v5
    v_xor_b32 v153, s52, v6
    s_lshl_b32 s52, s80, 6
    s_lshl3_add_u32 s52, s54, s52
    s_lshl_b32 s52, s52, 7
    s_add_u32 s52, s52, 14155776
    v_bfe_u32 v1, v0, 1, 3
    v_and_b32 v2, 1, v0
    v_lshl_add_u32 v1, v2, 5, v1
    v_lshl_add_u32 v154, v1, 7, s52
    s_mov_b32 s60, s74
    s_mov_b32 s61, s76
    s_mov_b32 s62, s72
    s_mov_b32 s63, s75
    s_mov_b32 s71, s77
    s_mov_b32 s73, s78
    v_mov_b32 v156, v4
    v_mov_b32 v157, v164
    v_mov_b32 v158, v5
    v_mov_b32 v159, v6
    v_mov_b32 v160, v162
    v_mov_b32 v161, v163
    s_mov_b32 s8, s30
    s_mov_b32 s9, s31
    s_mov_b32 s10, 4096
    s_mov_b32 s11, 0x00020000
    s_mov_b32 s55, s58
    v_and_b32 v1, 31, v0
    v_lshlrev_b32 v10, 2, v1
    v_lshlrev_b32 v1, 1, v1
    s_lshl_b32 s52, s83, 6
    buffer_load_ushort v13, v1, s[8:11], s52 offen
    s_lshl_b32 s68, s83, 7
    s_add_u32 s68, s68, 12582912
    s_lshr_b32 s52, s54, 1
    s_lshl1_add_u32 s52, s81, s52
    s_lshl_b32 s52, s52, 6
    s_lshl_b32 s53, s83, 15
    s_add_u32 s79, s52, s53
    s_lshl_b32 s52, s81, 7
    s_mul_i32 s53, s54, 14
    s_add_u32 s52, s52, s53
    s_lshl_b32 s52, s52, 7
    s_add_u32 s52, s52, 13893632
    v_lshrrev_b32 v1, 1, v0
    v_min_u32 v1, 13, v1
    v_and_b32 v2, 1, v0
    v_lshl_add_u32 v1, v2, 6, v1
    v_lshl_add_u32 v155, v1, 7, s52
    s_mov_b32 s8, s28
    s_mov_b32 s9, s29
    s_mov_b32 s10, 7340032
    s_mov_b32 s11, 0x00020000
    s_sub_u32 s54, s3, 8
    s_and_b32 s52, s2, 7
    s_lshr_b32 s82, s2, 3
    s_and_b32 s53, s52, 1
    s_mul_i32 s53, s53, 28
    s_add_u32 s53, s53, s82
    s_lshr_b32 s52, s52, 1
    s_mul_i32 s80, s52, 7
    s_lshr_b32 s52, s53, 3
    s_add_u32 s80, s80, s52
    s_and_b32 s81, s53, 7
    s_cmp_ge_u32 s82, 28
    s_cbranch_scc1 M_nog1
    s_mov_b32 s40, s24
    s_mov_b32 s41, s25
    s_mov_b32 s42, 7340032
    s_mov_b32 s43, 0x00020000
    s_mov_b32 s44, s26
    s_mov_b32 s45, s27
    s_mov_b32 s46, 3584
    s_mov_b32 s47, 0x00020000
    v_lshrrev_b32 v1, 3, v0
    v_and_b32 v2, 7, v0
    v_bfe_u32 v3, v0, 4, 1
    v_lshlrev_b32 v3, 2, v3
    v_xor_b32 v2, v2, v3
    v_mul_u32_u24 v4, 3584, v1
    v_lshl_add_u32 v4, v2, 4, v4
    v_add_u32 v164, 27648, v4
    v_lshlrev_b32 v7, 4, v0
    v_bfe_u32 v1, v0, 2, 2
    v_lshrrev_b32 v2, 5, v0
    v_lshl_add_u32 v3, v2, 3, v1
    v_lshlrev_b32 v3, 7, v3
    v_lshrrev_b32 v1, 1, v1
    s_bfe_u32 s52, s54, 65536
    v_xor_b32 v1, s52, v1
    v_lshl_add_u32 v3, v1, 6, v3
    v_bfe_u32 v1, v0, 4, 1
    v_lshl_add_u32 v3, v1, 5, v3
    v_and_b32 v1, 3, v0
    v_lshl_add_u32 v3, v1, 3, v3
    s_mul_i32 s58, s54, 14336
    s_add_u32 s58, s58, 81920
    v_add_u32 v5, s58, v3
    v_xor_b32 v6, 64, v5
    s_mul_i32 s74, s81, 4
    s_mul_i32 s52, s80, 1
    s_add_u32 s74, s74, s52
    s_and_b32 s74, s74, 31
    s_mul_i32 s76, s54, 1835008
    s_lshl_b32 s52, s80, 7
    s_add_u32 s76, s76, s52
    s_lshr_b32 s52, s54, 1
    s_lshl1_add_u32 s52, s81, s52
    s_lshl_b32 s77, s52, 17
    s_lshl_b32 s53, s54, 15
    s_add_u32 s77, s77, s53
    s_add_u32 s77, s77, 6291456
    s_xor_b32 s78, s77, 131072
    s_min_u32 s53, s77, s78
    s_sub_u32 s52, s77, s53
    v_add_u32 v162, s52, v7
    s_sub_u32 s52, s78, s53
    v_add_u32 v163, s52, v7
    s_mov_b32 s77, s53
    s_add_u32 s78, s77, 32768
    s_lshl_b32 s75, s74, 10
    s_add_u32 s75, s75, s77
    s_add_u32 s72, s76, 1835008
    s_mul_i32 s74, s74, 57344
    s_add_u32 s74, s74, s76
    v_lshrrev_b32 v1, 5, v0
    v_lshlrev_b32 v1, 3, v1
    s_and_b32 s53, s54, 1
    s_lshl1_add_u32 s83, s80, s53
    s_lshl_b32 s52, s83, 6
    buffer_load_dwordx2 v[16:17], v1, s[44:47], s52 offen offset:0
    buffer_load_dwordx2 v[18:19], v1, s[44:47], s52 offen offset:16
    buffer_load_dwordx2 v[20:21], v1, s[44:47], s52 offen offset:32
    buffer_load_dwordx2 v[22:23], v1, s[44:47], s52 offen offset:48
    s_lshr_b32 s52, s54, 1
    s_lshl1_add_u32 s52, s81, s52
    s_mul_i32 s64, s52, 112
    s_lshl1_add_u32 s64, s83, s64
    s_lshl_b32 s64, s64, 10
    s_add_u32 s64, s64, 8388608
    s_lshl_b32 s52, s52, 6
    s_add_u32 s52, s52, s83
    s_lshl_b32 s65, s52, 7
    s_add_u32 s65, s65, 13893632
    s_waitcnt vmcnt(0)
    v_lshlrev_b32 v88, 16, v16
    v_and_b32 v89, 0xffff0000, v16
    v_lshlrev_b32 v90, 16, v17
    v_and_b32 v91, 0xffff0000, v17
    v_lshlrev_b32 v92, 16, v18
    v_and_b32 v93, 0xffff0000, v18
    v_lshlrev_b32 v94, 16, v19
    v_and_b32 v95, 0xffff0000, v19
    v_lshlrev_b32 v96, 16, v20
    v_and_b32 v97, 0xffff0000, v20
    v_lshlrev_b32 v98, 16, v21
    v_and_b32 v99, 0xffff0000, v21
    v_lshlrev_b32 v100, 16, v22
    v_and_b32 v101, 0xffff0000, v22
    v_lshlrev_b32 v102, 16, v23
    v_and_b32 v103, 0xffff0000, v23
    s_lshl_b32 s52, s54, 13
    s_add_u32 s52, s52, 13697024
    v_lshl_add_u32 v9, v0, 7, s52
    v_and_b32 v1, 3, v0
    v_lshlrev_b32 v1, 2, v1
    v_add_u32 v1, 163776, v1
W_55:
    ds_read_b32 v2, v1
    s_waitcnt lgkmcnt(0)
    v_cmp_gt_u32 vcc, 10, v2
    s_cbranch_vccz W_56
    s_sleep 2
    s_sub_u32 s48, s48, 1
    s_cbranch_scc0 W_55
    s_mov_b32 s48, 0
W_56:
    v_mov_b32 v1, 163804
    s_mov_b32 s52, 24
GS_57:
    ds_read_b32 v2, v1
    s_waitcnt lgkmcnt(0)
    v_cmp_gt_u32 vcc, 13, v2
    s_cbranch_vccz GS_58
    s_sleep 2
    s_sub_u32 s52, s52, 1
    s_cbranch_scc0 GS_57
GS_58:
    buffer_load_dword v2, v9, s[4:7], 0 offen sc1
    s_add_u32 m0, s58, 0
    s_add_u32 s52, s74, 57344
    buffer_load_dwordx4 v4, s[40:43], s74 offen lds
    buffer_load_dwordx4 v164, s[40:43], s74 offen offset:1024 lds
    s_cmp_eq_u32 s52, s72
    s_cselect_b32 s74, s76, s52
    s_add_u32 m0, s58, 2048
    s_add_u32 s52, s74, 57344
    buffer_load_dwordx4 v4, s[40:43], s74 offen lds
    buffer_load_dwordx4 v164, s[40:43], s74 offen offset:1024 lds
    s_cmp_eq_u32 s52, s72
    s_cselect_b32 s74, s76, s52
    s_add_u32 m0, s58, 4096
    s_add_u32 s52, s74, 57344
    buffer_load_dwordx4 v4, s[40:43], s74 offen lds
    buffer_load_dwordx4 v164, s[40:43], s74 offen offset:1024 lds
    s_cmp_eq_u32 s52, s72
    s_cselect_b32 s74, s76, s52
    s_add_u32 m0, s58, 6144
    s_add_u32 s52, s74, 57344
    buffer_load_dwordx4 v4, s[40:43], s74 offen lds
    buffer_load_dwordx4 v164, s[40:43], s74 offen offset:1024 lds
    s_cmp_eq_u32 s52, s72
    s_cselect_b32 s74, s76, s52
    s_add_u32 m0, s58, 8192
    s_add_u32 s52, s74, 57344
    buffer_load_dwordx4 v4, s[40:43], s74 offen lds
    buffer_load_dwordx4 v164, s[40:43], s74 offen offset:1024 lds
    s_cmp_eq_u32 s52, s72
    s_cselect_b32 s74, s76, s52
    s_add_u32 m0, s58, 10240
    s_add_u32 s52, s74, 57344
    buffer_load_dwordx4 v4, s[40:43], s74 offen lds
    buffer_load_dwordx4 v164, s[40:43], s74 offen offset:1024 lds
    s_cmp_eq_u32 s52, s72
    s_cselect_b32 s74, s76, s52
    s_waitcnt vmcnt(12)
    v_cmp_ne_u32 vcc, s49, v2
    s_cbranch_vccz GW_60
GW_59:
    buffer_load_dword v2, v9, s[4:7], 0 offen sc1
    s_waitcnt vmcnt(0)
    v_cmp_ne_u32 vcc, s49, v2
    s_cbranch_vccz GW_60
    s_sleep 8
    s_sub_u32 s48, s48, 1
    s_cbranch_scc0 GW_59
    s_mov_b32 s48, 0
GW_60:
    s_setprio 0
    buffer_load_dwordx4 v[32:35], v162, s[4:7], s75 offen sc1
    s_add_u32 s53, s75, 1024
    buffer_load_dwordx4 v[36:39], v163, s[4:7], s75 offen sc1
    s_cmp_eq_u32 s53, s78
    s_cselect_b32 s75, s77, s53
    buffer_load_dwordx4 v[40:43], v162, s[4:7], s75 offen sc1
    s_add_u32 s53, s75, 1024
    buffer_load_dwordx4 v[44:47], v163, s[4:7], s75 offen sc1
    s_cmp_eq_u32 s53, s78
    s_cselect_b32 s75, s77, s53
    buffer_load_dwordx4 v[48:51], v162, s[4:7], s75 offen sc1
    s_add_u32 s53, s75, 1024
    buffer_load_dwordx4 v[52:55], v163, s[4:7], s75 offen sc1
    s_cmp_eq_u32 s53, s78
    s_cselect_b32 s75, s77, s53
    buffer_load_dwordx4 v[56:59], v162, s[4:7], s75 offen sc1
    s_add_u32 s53, s75, 1024
    buffer_load_dwordx4 v[60:63], v163, s[4:7], s75 offen sc1
    s_cmp_eq_u32 s53, s78
    s_cselect_b32 s75, s77, s53
    buffer_load_dwordx4 v[64:67], v162, s[4:7], s75 offen sc1
    s_add_u32 s53, s75, 1024
    buffer_load_dwordx4 v[68:71], v163, s[4:7], s75 offen sc1
    s_cmp_eq_u32 s53, s78
    s_cselect_b32 s75, s77, s53
    buffer_load_dwordx4 v[72:75], v162, s[4:7], s75 offen sc1
    s_add_u32 s53, s75, 1024
    buffer_load_dwordx4 v[76:79], v163, s[4:7], s75 offen sc1
    s_cmp_eq_u32 s53, s78
    s_cselect_b32 s75, s77, s53
    s_waitcnt vmcnt(10)
    ds_read_b64_tr_b16 v[16:17], v5 offset:0
    ds_read_b64_tr_b16 v[18:19], v5 offset:512
    ds_read_b64_tr_b16 v[20:21], v6 offset:0
    ds_read_b64_tr_b16 v[22:23], v6 offset:512
    s_waitcnt lgkmcnt(0)
    v_mfma_f32_32x32x16_bf16 v[88:103], v[16:19], v[32:35], v[88:103]
    s_waitcnt vmcnt(8)
    ds_read_b64_tr_b16 v[24:25], v5 offset:2048
    ds_read_b64_tr_b16 v[26:27], v5 offset:2560
    ds_read_b64_tr_b16 v[28:29], v6 offset:2048
    ds_read_b64_tr_b16 v[30:31], v6 offset:2560
    v_mfma_f32_32x32x16_bf16 v[104:119], v[20:23], v[32:35], 0
    s_add_u32 m0, s58, 12288
    s_add_u32 s52, s74, 57344
    buffer_load_dwordx4 v4, s[40:43], s74 offen lds
    v_mfma_f32_32x32x16_bf16 v[120:135], v[16:19], v[36:39], 0
    buffer_load_dwordx4 v164, s[40:43], s74 offen offset:1024 lds
    s_cmp_eq_u32 s52, s72
    s_cselect_b32 s74, s76, s52
    buffer_load_dwordx4 v[80:83], v162, s[4:7], s75 offen sc1
    s_add_u32 s53, s75, 1024
    v_mfma_f32_32x32x16_bf16 v[136:151], v[20:23], v[36:39], 0
    buffer_load_dwordx4 v[84:87], v163, s[4:7], s75 offen sc1
    s_cmp_eq_u32 s53, s78
    s_cselect_b32 s75, s77, s53
    s_waitcnt lgkmcnt(0)
    v_mfma_f32_32x32x16_bf16 v[88:103], v[24:27], v[40:43], v[88:103]
    s_waitcnt vmcnt(10)
    ds_read_b64_tr_b16 v[16:17], v5 offset:4096
    ds_read_b64_tr_b16 v[18:19], v5 offset:4608
    ds_read_b64_tr_b16 v[20:21], v6 offset:4096
    ds_read_b64_tr_b16 v[22:23], v6 offset:4608
    v_mfma_f32_32x32x16_bf16 v[104:119], v[28:31], v[40:43], v[104:119]
    s_add_u32 m0, s58, 0
    s_add_u32 s52, s74, 57344
    buffer_load_dwordx4 v4, s[40:43], s74 offen lds
    v_mfma_f32_32x32x16_bf16 v[120:135], v[24:27], v[44:47], v[120:135]
    buffer_load_dwordx4 v164, s[40:43], s74 offen offset:1024 lds
    s_cmp_eq_u32 s52, s72
    s_cselect_b32 s74, s76, s52
    buffer_load_dwordx4 v[32:35], v162, s[4:7], s75 offen sc1
    s_add_u32 s53, s75, 1024
    v_mfma_f32_32x32x16_bf16 v[136:151], v[28:31], v[44:47], v[136:151]
    buffer_load_dwordx4 v[36:39], v163, s[4:7], s75 offen sc1
    s_cmp_eq_u32 s53, s78
    s_cselect_b32 s75, s77, s53
    s_waitcnt lgkmcnt(0)
    v_mfma_f32_32x32x16_bf16 v[88:103], v[16:19], v[48:51], v[88:103]
    s_waitcnt vmcnt(12)
    ds_read_b64_tr_b16 v[24:25], v5 offset:6144
    ds_read_b64_tr_b16 v[26:27], v5 offset:6656
    ds_read_b64_tr_b16 v[28:29], v6 offset:6144
    ds_read_b64_tr_b16 v[30:31], v6 offset:6656
    v_mfma_f32_32x32x16_bf16 v[104:119], v[20:23], v[48:51], v[104:119]
    s_add_u32 m0, s58, 2048
    s_add_u32 s52, s74, 57344
    buffer_load_dwordx4 v4, s[40:43], s74 offen lds
    v_mfma_f32_32x32x16_bf16 v[120:135], v[16:19], v[52:55], v[120:135]
    buffer_load_dwordx4 v164, s[40:43], s74 offen offset:1024 lds
    s_cmp_eq_u32 s52, s72
    s_cselect_b32 s74, s76, s52
    buffer_load_dwordx4 v[40:43], v162, s[4:7], s75 offen sc1
    s_add_u32 s53, s75, 1024
    v_mfma_f32_32x32x16_bf16 v[136:151], v[20:23], v[52:55], v[136:151]
    buffer_load_dwordx4 v[44:47], v163, s[4:7], s75 offen sc1
    s_cmp_eq_u32 s53, s78
    s_cselect_b32 s75, s77, s53
    s_waitcnt lgkmcnt(0)
    v_mfma_f32_32x32x16_bf16 v[88:103], v[24:27], v[56:59], v[88:103]
    s_waitcnt vmcnt(14)
    ds_read_b64_tr_b16 v[16:17], v5 offset:8192
    ds_read_b64_tr_b16 v[18:19], v5 offset:8704
    ds_read_b64_tr_b16 v[20:21], v6 offset:8192
    ds_read_b64_tr_b16 v[22:23], v6 offset:8704
    v_mfma_f32_32x32x16_bf16 v[104:119], v[28:31], v[56:59], v[104:119]
    s_add_u32 m0, s58, 4096
    s_add_u32 s52, s74, 57344
    buffer_load_dwordx4 v4, s[40:43], s74 offen lds
    v_mfma_f32_32x32x16_bf16 v[120:135], v[24:27], v[60:63], v[120:135]
    buffer_load_dwordx4 v164, s[40:43], s74 offen offset:1024 lds
    s_cmp_eq_u32 s52, s72
    s_cselect_b32 s74, s76, s52
    buffer_load_dwordx4 v[48:51], v162, s[4:7], s75 offen sc1
    s_add_u32 s53, s75, 1024
    v_mfma_f32_32x32x16_bf16 v[136:151], v[28:31], v[60:63], v[136:151]
    buffer_load_dwordx4 v[52:55], v163, s[4:7], s75 offen sc1
    s_cmp_eq_u32 s53, s78
    s_cselect_b32 s75, s77, s53
    s_waitcnt lgkmcnt(0)
    v_mfma_f32_32x32x16_bf16 v[88:103], v[16:19], v[64:67], v[88:103]
    s_waitcnt vmcnt(16)
    ds_read_b64_tr_b16 v[24:25], v5 offset:10240
    ds_read_b64_tr_b16 v[26:27], v5 offset:10752
    ds_read_b64_tr_b16 v[28:29], v6 offset:10240
    ds_read_b64_tr_b16 v[30:31], v6 offset:10752
    v_mfma_f32_32x32x16_bf16 v[104:119], v[20:23], v[64:67], v[104:119]
    s_add_u32 m0, s58, 6144
    s_add_u32 s52, s74, 57344
    buffer_load_dwordx4 v4, s[40:43], s74 offen lds
    v_mfma_f32_32x32x16_bf16 v[120:135], v[16:19], v[68:71], v[120:135]
    buffer_load_dwordx4 v164, s[40:43], s74 offen offset:1024 lds
    s_cmp_eq_u32 s52, s72
    s_cselect_b32 s74, s76, s52
    buffer_load_dwordx4 v[56:59], v162, s[4:7], s75 offen sc1
    s_add_u32 s53, s75, 1024
    v_mfma_f32_32x32x16_bf16 v[136:151], v[20:23], v[68:71], v[136:151]
    buffer_load_dwordx4 v[60:63], v163, s[4:7], s75 offen sc1
    s_cmp_eq_u32 s53, s78
    s_cselect_b32 s75, s77, s53
    s_waitcnt lgkmcnt(0)
    v_mfma_f32_32x32x16_bf16 v[88:103], v[24:27], v[72:75], v[88:103]
    s_waitcnt vmcnt(16)
    ds_read_b64_tr_b16 v[16:17], v5 offset:12288
    ds_read_b64_tr_b16 v[18:19], v5 offset:12800
    ds_read_b64_tr_b16 v[20:21], v6 offset:12288
    ds_read_b64_tr_b16 v[22:23], v6 offset:12800
    v_mfma_f32_32x32x16_bf16 v[104:119], v[28:31], v[72:75], v[104:119]
    s_add_u32 m0, s58, 8192
    s_add_u32 s52, s74, 57344
    buffer_load_dwordx4 v4, s[40:43], s74 offen lds
    v_mfma_f32_32x32x16_bf16 v[120:135], v[24:27], v[76:79], v[120:135]
    buffer_load_dwordx4 v164, s[40:43], s74 offen offset:1024 lds
    s_cmp_eq_u32 s52, s72
    s_cselect_b32 s74, s76, s52
    buffer_load_dwordx4 v[64:67], v162, s[4:7], s75 offen sc1
    s_add_u32 s53, s75, 1024
    v_mfma_f32_32x32x16_bf16 v[136:151], v[28:31], v[76:79], v[136:151]
    buffer_load_dwordx4 v[68:71], v163, s[4:7], s75 offen sc1
    s_cmp_eq_u32 s53, s78
    s_cselect_b32 s75, s77, s53
    s_waitcnt lgkmcnt(0)
    v_mfma_f32_32x32x16_bf16 v[88:103], v[16:19], v[80:83], v[88:103]
    s_waitcnt vmcnt(16)
    ds_read_b64_tr_b16 v[24:25], v5 offset:0
    ds_read_b64_tr_b16 v[26:27], v5 offset:512
    ds_read_b64_tr_b16 v[28:29], v6 offset:0
    ds_read_b64_tr_b16 v[30:31], v6 offset:512
    v_mfma_f32_32x32x16_bf16 v[104:119], v[20:23], v[80:83], v[104:119]
    s_add_u32 m0, s58, 10240
    s_add_u32 s52, s74, 57344
    buffer_load_dwordx4 v4, s[40:43], s74 offen lds
    v_mfma_f32_32x32x16_bf16 v[120:135], v[16:19], v[84:87], v[120:135]
    buffer_load_dwordx4 v164, s[40:43], s74 offen offset:1024 lds
    s_cmp_eq_u32 s52, s72
    s_cselect_b32 s74, s76, s52
    buffer_load_dwordx4 v[72:75], v162, s[4:7], s75 offen sc1
    s_add_u32 s53, s75, 1024
    v_mfma_f32_32x32x16_bf16 v[136:151], v[20:23], v[84:87], v[136:151]
    buffer_load_dwordx4 v[76:79], v163, s[4:7], s75 offen sc1
    s_cmp_eq_u32 s53, s78
    s_cselect_b32 s75, s77, s53
    s_waitcnt lgkmcnt(0)
    v_mfma_f32_32x32x16_bf16 v[88:103], v[24:27], v[32:35], v[88:103]
    s_waitcnt vmcnt(16)
    ds_read_b64_tr_b16 v[16:17], v5 offset:2048
    ds_read_b64_tr_b16 v[18:19], v5 offset:2560
    ds_read_b64_tr_b16 v[20:21], v6 offset:2048
    ds_read_b64_tr_b16 v[22:23], v6 offset:2560
    v_mfma_f32_32x32x16_bf16 v[104:119], v[28:31], v[32:35], v[104:119]
    s_add_u32 m0, s58, 12288
    s_add_u32 s52, s74, 57344
    buffer_load_dwordx4 v4, s[40:43], s74 offen lds
    v_mfma_f32_32x32x16_bf16 v[120:135], v[24:27], v[36:39], v[120:135]
    buffer_load_dwordx4 v164, s[40:43], s74 offen offset:1024 lds
    s_cmp_eq_u32 s52, s72
    s_cselect_b32 s74, s76, s52
    buffer_load_dwordx4 v[80:83], v162, s[4:7], s75 offen sc1
    s_add_u32 s53, s75, 1024
    v_mfma_f32_32x32x16_bf16 v[136:151], v[28:31], v[36:39], v[136:151]
    buffer_load_dwordx4 v[84:87], v163, s[4:7], s75 offen sc1
    s_cmp_eq_u32 s53, s78
    s_cselect_b32 s75, s77, s53
    s_waitcnt lgkmcnt(0)
    v_mfma_f32_32x32x16_bf16 v[88:103], v[16:19], v[40:43], v[88:103]
    s_waitcnt vmcnt(16)
    ds_read_b64_tr_b16 v[24:25], v5 offset:4096
    ds_read_b64_tr_b16 v[26:27], v5 offset:4608
    ds_read_b64_tr_b16 v[28:29], v6 offset:4096
    ds_read_b64_tr_b16 v[30:31], v6 offset:4608
    v_mfma_f32_32x32x16_bf16 v[104:119], v[20:23], v[40:43], v[104:119]
    s_add_u32 m0, s58, 0
    s_add_u32 s52, s74, 57344
    buffer_load_dwordx4 v4, s[40:43], s74 offen lds
    v_mfma_f32_32x32x16_bf16 v[120:135], v[16:19], v[44:47], v[120:135]
    buffer_load_dwordx4 v164, s[40:43], s74 offen offset:1024 lds
    s_cmp_eq_u32 s52, s72
    s_cselect_b32 s74, s76, s52
    buffer_load_dwordx4 v[32:35], v162, s[4:7], s75 offen sc1
    s_add_u32 s53, s75, 1024
    v_mfma_f32_32x32x16_bf16 v[136:151], v[20:23], v[44:47], v[136:151]
    buffer_load_dwordx4 v[36:39], v163, s[4:7], s75 offen sc1
    s_cmp_eq_u32 s53, s78
    s_cselect_b32 s75, s77, s53
    s_waitcnt lgkmcnt(0)
    v_mfma_f32_32x32x16_bf16 v[88:103], v[24:27], v[48:51], v[88:103]
    s_waitcnt vmcnt(16)
    ds_read_b64_tr_b16 v[16:17], v5 offset:6144
    ds_read_b64_tr_b16 v[18:19], v5 offset:6656
    ds_read_b64_tr_b16 v[20:21], v6 offset:6144
    ds_read_b64_tr_b16 v[22:23], v6 offset:6656
    v_mfma_f32_32x32x16_bf16 v[104:119], v[28:31], v[48:51], v[104:119]
    s_add_u32 m0, s58, 2048
    s_add_u32 s52, s74, 57344
    buffer_load_dwordx4 v4, s[40:43], s74 offen lds
    v_mfma_f32_32x32x16_bf16 v[120:135], v[24:27], v[52:55], v[120:135]
    buffer_load_dwordx4 v164, s[40:43], s74 offen offset:1024 lds
    s_cmp_eq_u32 s52, s72
    s_cselect_b32 s74, s76, s52
    buffer_load_dwordx4 v[40:43], v162, s[4:7], s75 offen sc1
    s_add_u32 s53, s75, 1024
    v_mfma_f32_32x32x16_bf16 v[136:151], v[28:31], v[52:55], v[136:151]
    buffer_load_dwordx4 v[44:47], v163, s[4:7], s75 offen sc1
    s_cmp_eq_u32 s53, s78
    s_cselect_b32 s75, s77, s53
    s_waitcnt lgkmcnt(0)
    v_mfma_f32_32x32x16_bf16 v[88:103], v[16:19], v[56:59], v[88:103]
    s_waitcnt vmcnt(16)
    ds_read_b64_tr_b16 v[24:25], v5 offset:8192
    ds_read_b64_tr_b16 v[26:27], v5 offset:8704
    ds_read_b64_tr_b16 v[28:29], v6 offset:8192
    ds_read_b64_tr_b16 v[30:31], v6 offset:8704
    v_mfma_f32_32x32x16_bf16 v[104:119], v[20:23], v[56:59], v[104:119]
    s_add_u32 m0, s58, 4096
    s_add_u32 s52, s74, 57344
    buffer_load_dwordx4 v4, s[40:43], s74 offen lds
    v_mfma_f32_32x32x16_bf16 v[120:135], v[16:19], v[60:63], v[120:135]
    buffer_load_dwordx4 v164, s[40:43], s74 offen offset:1024 lds
    s_cmp_eq_u32 s52, s72
    s_cselect_b32 s74, s76, s52
    buffer_load_dwordx4 v[48:51], v162, s[4:7], s75 offen sc1
    s_add_u32 s53, s75, 1024
    v_mfma_f32_32x32x16_bf16 v[136:151], v[20:23], v[60:63], v[136:151]
    buffer_load_dwordx4 v[52:55], v163, s[4:7], s75 offen sc1
    s_cmp_eq_u32 s53, s78
    s_cselect_b32 s75, s77, s53
    s_waitcnt lgkmcnt(0)
    v_mfma_f32_32x32x16_bf16 v[88:103], v[24:27], v[64:67], v[88:103]
    s_waitcnt vmcnt(16)
    ds_read_b64_tr_b16 v[16:17], v5 offset:10240
    ds_read_b64_tr_b16 v[18:19], v5 offset:10752
    ds_read_b64_tr_b16 v[20:21], v6 offset:10240
    ds_read_b64_tr_b16 v[22:23], v6 offset:10752
    v_mfma_f32_32x32x16_bf16 v[104:119], v[28:31], v[64:67], v[104:119]
    s_add_u32 m0, s58, 6144
    s_add_u32 s52, s74, 57344
    buffer_load_dwordx4 v4, s[40:43], s74 offen lds
    v_mfma_f32_32x32x16_bf16 v[120:135], v[24:27], v[68:71], v[120:135]
    buffer_load_dwordx4 v164, s[40:43], s74 offen offset:1024 lds
    s_cmp_eq_u32 s52, s72
    s_cselect_b32 s74, s76, s52
    buffer_load_dwordx4 v[56:59], v162, s[4:7], s75 offen sc1
    s_add_u32 s53, s75, 1024
    v_mfma_f32_32x32x16_bf16 v[136:151], v[28:31], v[68:71], v[136:151]
    buffer_load_dwordx4 v[60:63], v163, s[4:7], s75 offen sc1
    s_cmp_eq_u32 s53, s78
    s_cselect_b32 s75, s77, s53
    s_waitcnt lgkmcnt(0)
    v_mfma_f32_32x32x16_bf16 v[88:103], v[16:19], v[72:75], v[88:103]
    s_waitcnt vmcnt(16)
    ds_read_b64_tr_b16 v[24:25], v5 offset:12288
    ds_read_b64_tr_b16 v[26:27], v5 offset:12800
    ds_read_b64_tr_b16 v[28:29], v6 offset:12288
    ds_read_b64_tr_b16 v[30:31], v6 offset:12800
    v_mfma_f32_32x32x16_bf16 v[104:119], v[20:23], v[72:75], v[104:119]
    s_add_u32 m0, s58, 8192
    s_add_u32 s52, s74, 57344
    buffer_load_dwordx4 v4, s[40:43], s74 offen lds
    v_mfma_f32_32x32x16_bf16 v[120:135], v[16:19], v[76:79], v[120:135]
    buffer_load_dwordx4 v164, s[40:43], s74 offen offset:1024 lds
    s_cmp_eq_u32 s52, s72
    s_cselect_b32 s74, s76, s52
    buffer_load_dwordx4 v[64:67], v162, s[4:7], s75 offen sc1
    s_add_u32 s53, s75, 1024
    v_mfma_f32_32x32x16_bf16 v[136:151], v[20:23], v[76:79], v[136:151]
    buffer_load_dwordx4 v[68:71], v163, s[4:7], s75 offen sc1
    s_cmp_eq_u32 s53, s78
    s_cselect_b32 s75, s77, s53
    s_waitcnt lgkmcnt(0)
    v_mfma_f32_32x32x16_bf16 v[88:103], v[24:27], v[80:83], v[88:103]
    s_waitcnt vmcnt(16)
    ds_read_b64_tr_b16 v[16:17], v5 offset:0
    ds_read_b64_tr_b16 v[18:19], v5 offset:512
    ds_read_b64_tr_b16 v[20:21], v6 offset:0
    ds_read_b64_tr_b16 v[22:23], v6 offset:512
    v_mfma_f32_32x32x16_bf16 v[104:119], v[28:31], v[80:83], v[104:119]
    s_add_u32 m0, s58, 10240
    s_add_u32 s52, s74, 57344
    buffer_load_dwordx4 v4, s[40:43], s74 offen lds
    v_mfma_f32_32x32x16_bf16 v[120:135], v[24:27], v[84:87], v[120:135]
    buffer_load_dwordx4 v164, s[40:43], s74 offen offset:1024 lds
    s_cmp_eq_u32 s52, s72
    s_cselect_b32 s74, s76, s52
    buffer_load_dwordx4 v[72:75], v162, s[4:7], s75 offen sc1
    s_add_u32 s53, s75, 1024
    v_mfma_f32_32x32x16_bf16 v[136:151], v[28:31], v[84:87], v[136:151]
    buffer_load_dwordx4 v[76:79], v163, s[4:7], s75 offen sc1
    s_cmp_eq_u32 s53, s78
    s_cselect_b32 s75, s77, s53
    s_waitcnt lgkmcnt(0)
    v_mfma_f32_32x32x16_bf16 v[88:103], v[16:19], v[32:35], v[88:103]
    s_waitcnt vmcnt(16)
    ds_read_b64_tr_b16 v[24:25], v5 offset:2048
    ds_read_b64_tr_b16 v[26:27], v5 offset:2560
    ds_read_b64_tr_b16 v[28:29], v6 offset:2048
    ds_read_b64_tr_b16 v[30:31], v6 offset:2560
    v_mfma_f32_32x32x16_bf16 v[104:119], v[20:23], v[32:35], v[104:119]
    s_add_u32 m0, s58, 12288
    s_add_u32 s52, s74, 57344
    buffer_load_dwordx4 v4, s[40:43], s74 offen lds
    v_mfma_f32_32x32x16_bf16 v[120:135], v[16:19], v[36:39], v[120:135]
    buffer_load_dwordx4 v164, s[40:43], s74 offen offset:1024 lds
    s_cmp_eq_u32 s52, s72
    s_cselect_b32 s74, s76, s52
    buffer_load_dwordx4 v[80:83], v162, s[4:7], s75 offen sc1
    s_add_u32 s53, s75, 1024
    v_mfma_f32_32x32x16_bf16 v[136:151], v[20:23], v[36:39], v[136:151]
    buffer_load_dwordx4 v[84:87], v163, s[4:7], s75 offen sc1
    s_cmp_eq_u32 s53, s78
    s_cselect_b32 s75, s77, s53
    s_waitcnt lgkmcnt(0)
    v_mfma_f32_32x32x16_bf16 v[88:103], v[24:27], v[40:43], v[88:103]
    s_waitcnt vmcnt(16)
    ds_read_b64_tr_b16 v[16:17], v5 offset:4096
    ds_read_b64_tr_b16 v[18:19], v5 offset:4608
    ds_read_b64_tr_b16 v[20:21], v6 offset:4096
    ds_read_b64_tr_b16 v[22:23], v6 offset:4608
    v_mfma_f32_32x32x16_bf16 v[104:119], v[28:31], v[40:43], v[104:119]
    s_add_u32 m0, s58, 0
    s_add_u32 s52, s74, 57344
    buffer_load_dwordx4 v4, s[40:43], s74 offen lds
    v_mfma_f32_32x32x16_bf16 v[120:135], v[24:27], v[44:47], v[120:135]
    buffer_load_dwordx4 v164, s[40:43], s74 offen offset:1024 lds
    s_cmp_eq_u32 s52, s72
    s_cselect_b32 s74, s76, s52
    buffer_load_dwordx4 v[32:35], v162, s[4:7], s75 offen sc1
    s_add_u32 s53, s75, 1024
    v_mfma_f32_32x32x16_bf16 v[136:151], v[28:31], v[44:47], v[136:151]
    buffer_load_dwordx4 v[36:39], v163, s[4:7], s75 offen sc1
    s_cmp_eq_u32 s53, s78
    s_cselect_b32 s75, s77, s53
    s_waitcnt lgkmcnt(0)
    v_mfma_f32_32x32x16_bf16 v[88:103], v[16:19], v[48:51], v[88:103]
    s_waitcnt vmcnt(16)
    ds_read_b64_tr_b16 v[24:25], v5 offset:6144
    ds_read_b64_tr_b16 v[26:27], v5 offset:6656
    ds_read_b64_tr_b16 v[28:29], v6 offset:6144
    ds_read_b64_tr_b16 v[30:31], v6 offset:6656
    v_mfma_f32_32x32x16_bf16 v[104:119], v[20:23], v[48:51], v[104:119]
    s_add_u32 m0, s58, 2048
    s_add_u32 s52, s74, 57344
    buffer_load_dwordx4 v4, s[40:43], s74 offen lds
    v_mfma_f32_32x32x16_bf16 v[120:135], v[16:19], v[52:55], v[120:135]
    buffer_load_dwordx4 v164, s[40:43], s74 offen offset:1024 lds
    s_cmp_eq_u32 s52, s72
    s_cselect_b32 s74, s76, s52
    buffer_load_dwordx4 v[40:43], v162, s[4:7], s75 offen sc1
    s_add_u32 s53, s75, 1024
    v_mfma_f32_32x32x16_bf16 v[136:151], v[20:23], v[52:55], v[136:151]
    buffer_load_dwordx4 v[44:47], v163, s[4:7], s75 offen sc1
    s_cmp_eq_u32 s53, s78
    s_cselect_b32 s75, s77, s53
    s_waitcnt lgkmcnt(0)
    v_mfma_f32_32x32x16_bf16 v[88:103], v[24:27], v[56:59], v[88:103]
    s_waitcnt vmcnt(16)
    ds_read_b64_tr_b16 v[16:17], v5 offset:8192
    ds_read_b64_tr_b16 v[18:19], v5 offset:8704
    ds_read_b64_tr_b16 v[20:21], v6 offset:8192
    ds_read_b64_tr_b16 v[22:23], v6 offset:8704
    v_mfma_f32_32x32x16_bf16 v[104:119], v[28:31], v[56:59], v[104:119]
    s_add_u32 m0, s58, 4096
    s_add_u32 s52, s74, 57344
    buffer_load_dwordx4 v4, s[40:43], s74 offen lds
    v_mfma_f32_32x32x16_bf16 v[120:135], v[24:27], v[60:63], v[120:135]
    buffer_load_dwordx4 v164, s[40:43], s74 offen offset:1024 lds
    s_cmp_eq_u32 s52, s72
    s_cselect_b32 s74, s76, s52
    buffer_load_dwordx4 v[48:51], v162, s[4:7], s75 offen sc1
    s_add_u32 s53, s75, 1024
    v_mfma_f32_32x32x16_bf16 v[136:151], v[28:31], v[60:63], v[136:151]
    buffer_load_dwordx4 v[52:55], v163, s[4:7], s75 offen sc1
    s_cmp_eq_u32 s53, s78
    s_cselect_b32 s75, s77, s53
    s_waitcnt lgkmcnt(0)
    v_mfma_f32_32x32x16_bf16 v[88:103], v[16:19], v[64:67], v[88:103]
    s_waitcnt vmcnt(16)
    ds_read_b64_tr_b16 v[24:25], v5 offset:10240
    ds_read_b64_tr_b16 v[26:27], v5 offset:10752
    ds_read_b64_tr_b16 v[28:29], v6 offset:10240
    ds_read_b64_tr_b16 v[30:31], v6 offset:10752
    v_mfma_f32_32x32x16_bf16 v[104:119], v[20:23], v[64:67], v[104:119]
    s_add_u32 m0, s58, 6144
    s_add_u32 s52, s74, 57344
    buffer_load_dwordx4 v4, s[40:43], s74 offen lds
    v_mfma_f32_32x32x16_bf16 v[120:135], v[16:19], v[68:71], v[120:135]
    buffer_load_dwordx4 v164, s[40:43], s74 offen offset:1024 lds
    s_cmp_eq_u32 s52, s72
    s_cselect_b32 s74, s76, s52
    buffer_load_dwordx4 v[56:59], v162, s[4:7], s75 offen sc1
    s_add_u32 s53, s75, 1024
    v_mfma_f32_32x32x16_bf16 v[136:151], v[20:23], v[68:71], v[136:151]
    buffer_load_dwordx4 v[60:63], v163, s[4:7], s75 offen sc1
    s_cmp_eq_u32 s53, s78
    s_cselect_b32 s75, s77, s53
    s_waitcnt lgkmcnt(0)
    v_mfma_f32_32x32x16_bf16 v[88:103], v[24:27], v[72:75], v[88:103]
    s_waitcnt vmcnt(16)
    ds_read_b64_tr_b16 v[16:17], v5 offset:12288
    ds_read_b64_tr_b16 v[18:19], v5 offset:12800
    ds_read_b64_tr_b16 v[20:21], v6 offset:12288
    ds_read_b64_tr_b16 v[22:23], v6 offset:12800
    v_mfma_f32_32x32x16_bf16 v[104:119], v[28:31], v[72:75], v[104:119]
    s_add_u32 m0, s58, 8192
    s_add_u32 s52, s74, 57344
    buffer_load_dwordx4 v4, s[40:43], s74 offen lds
    v_mfma_f32_32x32x16_bf16 v[120:135], v[24:27], v[76:79], v[120:135]
    buffer_load_dwordx4 v164, s[40:43], s74 offen offset:1024 lds
    s_cmp_eq_u32 s52, s72
    s_cselect_b32 s74, s76, s52
    buffer_load_dwordx4 v[64:67], v162, s[4:7], s75 offen sc1
    s_add_u32 s53, s75, 1024
    v_mfma_f32_32x32x16_bf16 v[136:151], v[28:31], v[76:79], v[136:151]
    buffer_load_dwordx4 v[68:71], v163, s[4:7], s75 offen sc1
    s_cmp_eq_u32 s53, s78
    s_cselect_b32 s75, s77, s53
    s_waitcnt lgkmcnt(0)
    v_mfma_f32_32x32x16_bf16 v[88:103], v[16:19], v[80:83], v[88:103]
    s_waitcnt vmcnt(16)
    ds_read_b64_tr_b16 v[24:25], v5 offset:0
    ds_read_b64_tr_b16 v[26:27], v5 offset:512
    ds_read_b64_tr_b16 v[28:29], v6 offset:0
    ds_read_b64_tr_b16 v[30:31], v6 offset:512
    v_mfma_f32_32x32x16_bf16 v[104:119], v[20:23], v[80:83], v[104:119]
    s_add_u32 m0, s58, 10240
    s_add_u32 s52, s74, 57344
    buffer_load_dwordx4 v4, s[40:43], s74 offen lds
    v_mfma_f32_32x32x16_bf16 v[120:135], v[16:19], v[84:87], v[120:135]
    buffer_load_dwordx4 v164, s[40:43], s74 offen offset:1024 lds
    s_cmp_eq_u32 s52, s72
    s_cselect_b32 s74, s76, s52
    buffer_load_dwordx4 v[72:75], v162, s[4:7], s75 offen sc1
    s_add_u32 s53, s75, 1024
    v_mfma_f32_32x32x16_bf16 v[136:151], v[20:23], v[84:87], v[136:151]
    buffer_load_dwordx4 v[76:79], v163, s[4:7], s75 offen sc1
    s_cmp_eq_u32 s53, s78
    s_cselect_b32 s75, s77, s53
    s_waitcnt lgkmcnt(0)
    v_mfma_f32_32x32x16_bf16 v[88:103], v[24:27], v[32:35], v[88:103]
    s_waitcnt vmcnt(16)
    ds_read_b64_tr_b16 v[16:17], v5 offset:2048
    ds_read_b64_tr_b16 v[18:19], v5 offset:2560
    ds_read_b64_tr_b16 v[20:21], v6 offset:2048
    ds_read_b64_tr_b16 v[22:23], v6 offset:2560
    v_mfma_f32_32x32x16_bf16 v[104:119], v[28:31], v[32:35], v[104:119]
    s_add_u32 m0, s58, 12288
    s_add_u32 s52, s74, 57344
    buffer_load_dwordx4 v4, s[40:43], s74 offen lds
    v_mfma_f32_32x32x16_bf16 v[120:135], v[24:27], v[36:39], v[120:135]
    buffer_load_dwordx4 v164, s[40:43], s74 offen offset:1024 lds
    s_cmp_eq_u32 s52, s72
    s_cselect_b32 s74, s76, s52
    buffer_load_dwordx4 v[80:83], v162, s[4:7], s75 offen sc1
    s_add_u32 s53, s75, 1024
    v_mfma_f32_32x32x16_bf16 v[136:151], v[28:31], v[36:39], v[136:151]
    buffer_load_dwordx4 v[84:87], v163, s[4:7], s75 offen sc1
    s_cmp_eq_u32 s53, s78
    s_cselect_b32 s75, s77, s53
    s_waitcnt lgkmcnt(0)
    v_mfma_f32_32x32x16_bf16 v[88:103], v[16:19], v[40:43], v[88:103]
    s_waitcnt vmcnt(16)
    ds_read_b64_tr_b16 v[24:25], v5 offset:4096
    ds_read_b64_tr_b16 v[26:27], v5 offset:4608
    ds_read_b64_tr_b16 v[28:29], v6 offset:4096
    ds_read_b64_tr_b16 v[30:31], v6 offset:4608
    v_mfma_f32_32x32x16_bf16 v[104:119], v[20:23], v[40:43], v[104:119]
    s_add_u32 m0, s58, 0
    s_add_u32 s52, s74, 57344
    buffer_load_dwordx4 v4, s[40:43], s74 offen lds
    v_mfma_f32_32x32x16_bf16 v[120:135], v[16:19], v[44:47], v[120:135]
    buffer_load_dwordx4 v164, s[40:43], s74 offen offset:1024 lds
    s_cmp_eq_u32 s52, s72
    s_cselect_b32 s74, s76, s52
    buffer_load_dwordx4 v[32:35], v162, s[4:7], s75 offen sc1
    s_add_u32 s53, s75, 1024
    v_mfma_f32_32x32x16_bf16 v[136:151], v[20:23], v[44:47], v[136:151]
    buffer_load_dwordx4 v[36:39], v163, s[4:7], s75 offen sc1
    s_cmp_eq_u32 s53, s78
    s_cselect_b32 s75, s77, s53
    s_waitcnt lgkmcnt(0)
    v_mfma_f32_32x32x16_bf16 v[88:103], v[24:27], v[48:51], v[88:103]
    s_waitcnt vmcnt(16)
    ds_read_b64_tr_b16 v[16:17], v5 offset:6144
    ds_read_b64_tr_b16 v[18:19], v5 offset:6656
    ds_read_b64_tr_b16 v[20:21], v6 offset:6144
    ds_read_b64_tr_b16 v[22:23], v6 offset:6656
    v_mfma_f32_32x32x16_bf16 v[104:119], v[28:31], v[48:51], v[104:119]
    s_add_u32 m0, s58, 2048
    s_add_u32 s52, s74, 57344
    buffer_load_dwordx4 v4, s[40:43], s74 offen lds
    v_mfma_f32_32x32x16_bf16 v[120:135], v[24:27], v[52:55], v[120:135]
    buffer_load_dwordx4 v164, s[40:43], s74 offen offset:1024 lds
    s_cmp_eq_u32 s52, s72
    s_cselect_b32 s74, s76, s52
    buffer_load_dwordx4 v[40:43], v162, s[4:7], s75 offen sc1
    s_add_u32 s53, s75, 1024
    v_mfma_f32_32x32x16_bf16 v[136:151], v[28:31], v[52:55], v[136:151]
    buffer_load_dwordx4 v[44:47], v163, s[4:7], s75 offen sc1
    s_cmp_eq_u32 s53, s78
    s_cselect_b32 s75, s77, s53
    s_waitcnt lgkmcnt(0)
    v_mfma_f32_32x32x16_bf16 v[88:103], v[16:19], v[56:59], v[88:103]
    s_waitcnt vmcnt(16)
    ds_read_b64_tr_b16 v[24:25], v5 offset:8192
    ds_read_b64_tr_b16 v[26:27], v5 offset:8704
    ds_read_b64_tr_b16 v[28:29], v6 offset:8192
    ds_read_b64_tr_b16 v[30:31], v6 offset:8704
    v_mfma_f32_32x32x16_bf16 v[104:119], v[20:23], v[56:59], v[104:119]
    s_add_u32 m0, s58, 4096
    s_add_u32 s52, s74, 57344
    buffer_load_dwordx4 v4, s[40:43], s74 offen lds
    v_mfma_f32_32x32x16_bf16 v[120:135], v[16:19], v[60:63], v[120:135]
    buffer_load_dwordx4 v164, s[40:43], s74 offen offset:1024 lds
    s_cmp_eq_u32 s52, s72
    s_cselect_b32 s74, s76, s52
    buffer_load_dwordx4 v[48:51], v162, s[4:7], s75 offen sc1
    s_add_u32 s53, s75, 1024
    v_mfma_f32_32x32x16_bf16 v[136:151], v[20:23], v[60:63], v[136:151]
    buffer_load_dwordx4 v[52:55], v163, s[4:7], s75 offen sc1
    s_cmp_eq_u32 s53, s78
    s_cselect_b32 s75, s77, s53
    s_waitcnt lgkmcnt(0)
    v_mfma_f32_32x32x16_bf16 v[88:103], v[24:27], v[64:67], v[88:103]
    s_waitcnt vmcnt(16)
    ds_read_b64_tr_b16 v[16:17], v5 offset:10240
    ds_read_b64_tr_b16 v[18:19], v5 offset:10752
    ds_read_b64_tr_b16 v[20:21], v6 offset:10240
    ds_read_b64_tr_b16 v[22:23], v6 offset:10752
    v_mfma_f32_32x32x16_bf16 v[104:119], v[28:31], v[64:67], v[104:119]
    s_add_u32 m0, s58, 6144
    s_add_u32 s52, s74, 57344
    buffer_load_dwordx4 v4, s[40:43], s74 offen lds
    v_mfma_f32_32x32x16_bf16 v[120:135], v[24:27], v[68:71], v[120:135]
    buffer_load_dwordx4 v164, s[40:43], s74 offen offset:1024 lds
    s_cmp_eq_u32 s52, s72
    s_cselect_b32 s74, s76, s52
    buffer_load_dwordx4 v[56:59], v162, s[4:7], s75 offen sc1
    s_add_u32 s53, s75, 1024
    v_mfma_f32_32x32x16_bf16 v[136:151], v[28:31], v[68:71], v[136:151]
    buffer_load_dwordx4 v[60:63], v163, s[4:7], s75 offen sc1
    s_cmp_eq_u32 s53, s78
    s_cselect_b32 s75, s77, s53
    s_waitcnt lgkmcnt(0)
    v_mfma_f32_32x32x16_bf16 v[88:103], v[16:19], v[72:75], v[88:103]
    s_waitcnt vmcnt(16)
    ds_read_b64_tr_b16 v[24:25], v5 offset:12288
    ds_read_b64_tr_b16 v[26:27], v5 offset:12800
    ds_read_b64_tr_b16 v[28:29], v6 offset:12288
    ds_read_b64_tr_b16 v[30:31], v6 offset:12800
    v_mfma_f32_32x32x16_bf16 v[104:119], v[20:23], v[72:75], v[104:119]
    v_mfma_f32_32x32x16_bf16 v[120:135], v[16:19], v[76:79], v[120:135]
    v_mfma_f32_32x32x16_bf16 v[136:151], v[20:23], v[76:79], v[136:151]
    s_waitcnt lgkmcnt(0)
    v_mfma_f32_32x32x16_bf16 v[88:103], v[24:27], v[80:83], v[88:103]
    s_waitcnt vmcnt(12)
    ds_read_b64_tr_b16 v[16:17], v5 offset:0
    ds_read_b64_tr_b16 v[18:19], v5 offset:512
    ds_read_b64_tr_b16 v[20:21], v6 offset:0
    ds_read_b64_tr_b16 v[22:23], v6 offset:512
    v_mfma_f32_32x32x16_bf16 v[104:119], v[28:31], v[80:83], v[104:119]
    v_mfma_f32_32x32x16_bf16 v[120:135], v[24:27], v[84:87], v[120:135]
    v_mfma_f32_32x32x16_bf16 v[136:151], v[28:31], v[84:87], v[136:151]
    s_waitcnt lgkmcnt(0)
    v_mfma_f32_32x32x16_bf16 v[88:103], v[16:19], v[32:35], v[88:103]
    s_waitcnt vmcnt(8)
    ds_read_b64_tr_b16 v[24:25], v5 offset:2048
    ds_read_b64_tr_b16 v[26:27], v5 offset:2560
    ds_read_b64_tr_b16 v[28:29], v6 offset:2048
    ds_read_b64_tr_b16 v[30:31], v6 offset:2560
    v_mfma_f32_32x32x16_bf16 v[104:119], v[20:23], v[32:35], v[104:119]
    v_mfma_f32_32x32x16_bf16 v[120:135], v[16:19], v[36:39], v[120:135]
    v_mfma_f32_32x32x16_bf16 v[136:151], v[20:23], v[36:39], v[136:151]
    s_waitcnt lgkmcnt(0)
    v_mfma_f32_32x32x16_bf16 v[88:103], v[24:27], v[40:43], v[88:103]
    s_waitcnt vmcnt(4)
    ds_read_b64_tr_b16 v[16:17], v5 offset:4096
    ds_read_b64_tr_b16 v[18:19], v5 offset:4608
    ds_read_b64_tr_b16 v[20:21], v6 offset:4096
    ds_read_b64_tr_b16 v[22:23], v6 offset:4608
    v_mfma_f32_32x32x16_bf16 v[104:119], v[28:31], v[40:43], v[104:119]
    v_mfma_f32_32x32x16_bf16 v[120:135], v[24:27], v[44:47], v[120:135]
    v_mfma_f32_32x32x16_bf16 v[136:151], v[28:31], v[44:47], v[136:151]
    s_waitcnt lgkmcnt(0)
    v_mfma_f32_32x32x16_bf16 v[88:103], v[16:19], v[48:51], v[88:103]
    s_waitcnt vmcnt(0)
    ds_read_b64_tr_b16 v[24:25], v5 offset:6144
    ds_read_b64_tr_b16 v[26:27], v5 offset:6656
    ds_read_b64_tr_b16 v[28:29], v6 offset:6144
    ds_read_b64_tr_b16 v[30:31], v6 offset:6656
    v_mfma_f32_32x32x16_bf16 v[104:119], v[20:23], v[48:51], v[104:119]
    v_mfma_f32_32x32x16_bf16 v[120:135], v[16:19], v[52:55], v[120:135]
    v_mfma_f32_32x32x16_bf16 v[136:151], v[20:23], v[52:55], v[136:151]
    s_waitcnt lgkmcnt(0)
    v_mfma_f32_32x32x16_bf16 v[88:103], v[24:27], v[56:59], v[88:103]
    v_mfma_f32_32x32x16_bf16 v[104:119], v[28:31], v[56:59], v[104:119]
    v_mfma_f32_32x32x16_bf16 v[120:135], v[24:27], v[60:63], v[120:135]
    v_mfma_f32_32x32x16_bf16 v[136:151], v[28:31], v[60:63], v[136:151]
    s_setprio 3
    v_lshl_add_u32 v1, v0, 4, s58
    s_nop 10
    ds_write_b128 v1, v[104:107] offset:0
    ds_write_b128 v1, v[108:111] offset:1024
    ds_write_b128 v1, v[112:115] offset:2048
    ds_write_b128 v1, v[116:119] offset:3072
    ds_write_b128 v1, v[120:123] offset:4096
    ds_write_b128 v1, v[124:127] offset:5120
    ds_write_b128 v1, v[128:131] offset:6144
    ds_write_b128 v1, v[132:135] offset:7168
    ds_write_b128 v1, v[136:139] offset:8192
    ds_write_b128 v1, v[140:143] offset:9216
    ds_write_b128 v1, v[144:147] offset:10240
    ds_write_b128 v1, v[148:151] offset:11264
    v_mov_b32 v2, 3
    ds_write_b32 v14, v2
    s_xor_b32 s52, s54, 1
    s_mul_i32 s52, s52, 14336
    s_add_u32 s52, s52, 81920
    v_lshl_add_u32 v24, v0, 4, s52
    s_xor_b32 s52, s54, 2
    s_mul_i32 s52, s52, 14336
    s_add_u32 s52, s52, 86016
    v_lshl_add_u32 v25, v0, 4, s52
    s_xor_b32 s52, s54, 3
    s_mul_i32 s52, s52, 14336
    s_add_u32 s52, s52, 90112
    v_lshl_add_u32 v26, v0, 4, s52
W_61:
    ds_read_b32 v2, v15
    s_waitcnt lgkmcnt(0)
    v_cmp_gt_u32 vcc, 3, v2
    s_cbranch_vccz W_62
    s_sub_u32 s48, s48, 1
    s_cbranch_scc0 W_61
    s_mov_b32 s48, 0
W_62:
    ds_read_b128 v[104:107], v24 offset:0
    ds_read_b128 v[108:111], v24 offset:1024
    ds_read_b128 v[112:115], v24 offset:2048
    ds_read_b128 v[116:119], v24 offset:3072
    ds_read_b128 v[120:123], v25 offset:0
    ds_read_b128 v[124:127], v25 offset:1024
    ds_read_b128 v[128:131], v25 offset:2048
    ds_read_b128 v[132:135], v25 offset:3072
    ds_read_b128 v[136:139], v26 offset:0
    ds_read_b128 v[140:143], v26 offset:1024
    ds_read_b128 v[144:147], v26 offset:2048
    ds_read_b128 v[148:151], v26 offset:3072
    v_mov_b32 v2, 4
    ds_write_b32 v14, v2
    s_waitcnt lgkmcnt(9)
    v_pk_add_f32 v[88:89], v[88:89], v[104:105]
    v_pk_add_f32 v[90:91], v[90:91], v[106:107]
    v_pk_add_f32 v[92:93], v[92:93], v[108:109]
    v_pk_add_f32 v[94:95], v[94:95], v[110:111]
    v_pk_add_f32 v[96:97], v[96:97], v[112:113]
    v_pk_add_f32 v[98:99], v[98:99], v[114:115]
    v_pk_add_f32 v[100:101], v[100:101], v[116:117]
    v_pk_add_f32 v[102:103], v[102:103], v[118:119]
    s_waitcnt lgkmcnt(5)
    v_pk_add_f32 v[88:89], v[88:89], v[120:121]
    v_pk_add_f32 v[90:91], v[90:91], v[122:123]
    v_pk_add_f32 v[92:93], v[92:93], v[124:125]
    v_pk_add_f32 v[94:95], v[94:95], v[126:127]
    v_pk_add_f32 v[96:97], v[96:97], v[128:129]
    v_pk_add_f32 v[98:99], v[98:99], v[130:131]
    v_pk_add_f32 v[100:101], v[100:101], v[132:133]
    v_pk_add_f32 v[102:103], v[102:103], v[134:135]
    s_waitcnt lgkmcnt(1)
    v_pk_add_f32 v[88:89], v[88:89], v[136:137]
    v_pk_add_f32 v[90:91], v[90:91], v[138:139]
    v_pk_add_f32 v[92:93], v[92:93], v[140:141]
    v_pk_add_f32 v[94:95], v[94:95], v[142:143]
    v_pk_add_f32 v[96:97], v[96:97], v[144:145]
    v_pk_add_f32 v[98:99], v[98:99], v[146:147]
    v_pk_add_f32 v[100:101], v[100:101], v[148:149]
    v_pk_add_f32 v[102:103], v[102:103], v[150:151]
    s_mov_b32 s52, 0xbdd2d3e8
    s_mov_b32 s53, s52
    s_mov_b32 s56, 1.0
    s_mov_b32 s57, 1.0
    v_mov_b32 v2, 0xc0135761
    v_mov_b32 v3, v2
    v_pk_mul_f32 v[104:105], v[88:89], v[88:89]
    v_pk_mul_f32 v[106:107], v[90:91], v[90:91]
    v_pk_mul_f32 v[108:109], v[92:93], v[92:93]
    v_pk_mul_f32 v[110:111], v[94:95], v[94:95]
    v_pk_mul_f32 v[112:113], v[96:97], v[96:97]
    v_pk_mul_f32 v[114:115], v[98:99], v[98:99]
    v_pk_mul_f32 v[116:117], v[100:101], v[100:101]
    v_pk_mul_f32 v[118:119], v[102:103], v[102:103]
    v_pk_fma_f32 v[104:105], v[104:105], s[52:53], v[2:3]
    v_pk_fma_f32 v[106:107], v[106:107], s[52:53], v[2:3]
    v_pk_fma_f32 v[108:109], v[108:109], s[52:53], v[2:3]
    v_pk_fma_f32 v[110:111], v[110:111], s[52:53], v[2:3]
    v_pk_fma_f32 v[112:113], v[112:113], s[52:53], v[2:3]
    v_pk_fma_f32 v[114:115], v[114:115], s[52:53], v[2:3]
    v_pk_fma_f32 v[116:117], v[116:117], s[52:53], v[2:3]
    v_pk_fma_f32 v[118:119], v[118:119], s[52:53], v[2:3]
    v_pk_mul_f32 v[104:105], v[104:105], v[88:89]
    v_pk_mul_f32 v[106:107], v[106:107], v[90:91]
    v_pk_mul_f32 v[108:109], v[108:109], v[92:93]
    v_pk_mul_f32 v[110:111], v[110:111], v[94:95]
    v_pk_mul_f32 v[112:113], v[112:113], v[96:97]
    v_pk_mul_f32 v[114:115], v[114:115], v[98:99]
    v_pk_mul_f32 v[116:117], v[116:117], v[100:101]
    v_pk_mul_f32 v[118:119], v[118:119], v[102:103]
    v_exp_f32 v104, v104
    v_exp_f32 v105, v105
    v_exp_f32 v106, v106
    v_exp_f32 v107, v107
    v_exp_f32 v108, v108
    v_exp_f32 v109, v109
    v_exp_f32 v110, v110
    v_exp_f32 v111, v111
    v_exp_f32 v112, v112
    v_exp_f32 v113, v113
    v_exp_f32 v114, v114
    v_exp_f32 v115, v115
    v_exp_f32 v116, v116
    v_exp_f32 v117, v117
    v_exp_f32 v118, v118
    v_exp_f32 v119, v119
    v_pk_add_f32 v[104:105], v[104:105], s[56:57]
    v_pk_add_f32 v[106:107], v[106:107], s[56:57]
    v_pk_add_f32 v[108:109], v[108:109], s[56:57]
    v_pk_add_f32 v[110:111], v[110:111], s[56:57]
    v_pk_add_f32 v[112:113], v[112:113], s[56:57]
    v_pk_add_f32 v[114:115], v[114:115], s[56:57]
    v_pk_add_f32 v[116:117], v[116:117], s[56:57]
    v_pk_add_f32 v[118:119], v[118:119], s[56:57]
    v_rcp_f32 v104, v104
    v_rcp_f32 v105, v105
    v_rcp_f32 v106, v106
    v_rcp_f32 v107, v107
    v_rcp_f32 v108, v108
    v_rcp_f32 v109, v109
    v_rcp_f32 v110, v110
    v_rcp_f32 v111, v111
    v_rcp_f32 v112, v112
    v_rcp_f32 v113, v113
    v_rcp_f32 v114, v114
    v_rcp_f32 v115, v115
    v_rcp_f32 v116, v116
    v_rcp_f32 v117, v117
    v_rcp_f32 v118, v118
    v_rcp_f32 v119, v119
    v_pk_mul_f32 v[88:89], v[88:89], v[104:105]
    v_pk_mul_f32 v[90:91], v[90:91], v[106:107]
    v_pk_mul_f32 v[92:93], v[92:93], v[108:109]
    v_pk_mul_f32 v[94:95], v[94:95], v[110:111]
    v_pk_mul_f32 v[96:97], v[96:97], v[112:113]
    v_pk_mul_f32 v[98:99], v[98:99], v[114:115]
    v_pk_mul_f32 v[100:101], v[100:101], v[116:117]
    v_pk_mul_f32 v[102:103], v[102:103], v[118:119]
    v_cvt_pk_bf16_f32 v16, v88, v89
    v_cvt_pk_bf16_f32 v17, v90, v91
    v_cvt_pk_bf16_f32 v18, v92, v93
    v_cvt_pk_bf16_f32 v19, v94, v95
    v_cvt_pk_bf16_f32 v20, v96, v97
    v_cvt_pk_bf16_f32 v21, v98, v99
    v_cvt_pk_bf16_f32 v22, v100, v101
    v_cvt_pk_bf16_f32 v23, v102, v103
    v_min_u32 v16, -2, v16
    v_min_u32 v20, -2, v20
    buffer_store_dwordx4 v[16:19], v7, s[4:7], s64 offen sc1
    buffer_store_dwordx4 v[20:23], v7, s[4:7], s64 offen offset:1024 sc1
    v_mov_b32 v1, s49
    v_cmp_eq_u32 vcc, 0, v0
    v_mov_b32 v2, 0x7ffffff0
    s_nop 0
    v_cndmask_b32 v2, v2, 0, vcc
    s_waitcnt vmcnt(0)
    buffer_store_dword v1, v2, s[4:7], s65 offen sc1
    s_branch M_g2
M_nog1:
    v_and_b32 v1, 3, v0
    v_lshlrev_b32 v1, 2, v1
    v_add_u32 v1, 163776, v1
W_63:
    ds_read_b32 v2, v1
    s_waitcnt lgkmcnt(0)
    v_cmp_gt_u32 vcc, 10, v2
    s_cbranch_vccz W_64
    s_sleep 2
    s_sub_u32 s48, s48, 1
    s_cbranch_scc0 W_63
    s_mov_b32 s48, 0
W_64:
    v_mov_b32 v1, 163804
    s_mov_b32 s52, 24
GS_65:
    ds_read_b32 v2, v1
    s_waitcnt lgkmcnt(0)
    v_cmp_gt_u32 vcc, 13, v2
    s_cbranch_vccz GS_66
    s_sleep 2
    s_sub_u32 s52, s52, 1
    s_cbranch_scc0 GS_65
GS_66:
    s_mov_b32 s40, s28
    s_mov_b32 s41, s29
    s_mov_b32 s42, 7340032
    s_mov_b32 s43, 0x00020000
    s_and_b32 s59, s2, 7
    s_lshl_b32 s59, s59, 9
    v_and_b32 v1, 7, v0
    v_lshlrev_b32 v1, 2, v1
    v_add_u32 v1, 163776, v1
W_67:
    ds_read_b32 v2, v1
    s_waitcnt lgkmcnt(0)
    v_cmp_gt_u32 vcc, 15, v2
    s_cbranch_vccz W_68
    s_sleep 2
    s_sub_u32 s48, s48, 1
    s_cbranch_scc0 W_67
    s_mov_b32 s48, 0
W_68:
    v_lshrrev_b32 v4, 5, v0
    v_mul_u32_u24 v4, 4096, v4
    v_and_b32 v5, 31, v0
    v_lshl_add_u32 v4, v5, 4, v4
    s_sub_u32 s52, s82, 28
    s_lshl2_add_u32 s52, s52, s54
    s_mul_i32 s56, s52, 458752
    s_add_u32 s56, s56, s59
    s_mov_b32 s57, 7
WM_69:
    buffer_load_dwordx4 v[32:35], v4, s[40:43], s56 offen
    s_add_u32 s56, s56, 8192
    s_waitcnt vmcnt(7)
    buffer_load_dwordx4 v[36:39], v4, s[40:43], s56 offen
    s_add_u32 s56, s56, 8192
    s_waitcnt vmcnt(7)
    buffer_load_dwordx4 v[40:43], v4, s[40:43], s56 offen
    s_add_u32 s56, s56, 8192
    s_waitcnt vmcnt(7)
    buffer_load_dwordx4 v[44:47], v4, s[40:43], s56 offen
    s_add_u32 s56, s56, 8192
    s_waitcnt vmcnt(7)
    buffer_load_dwordx4 v[48:51], v4, s[40:43], s56 offen
    s_add_u32 s56, s56, 8192
    s_waitcnt vmcnt(7)
    buffer_load_dwordx4 v[52:55], v4, s[40:43], s56 offen
    s_add_u32 s56, s56, 8192
    s_waitcnt vmcnt(7)
    buffer_load_dwordx4 v[56:59], v4, s[40:43], s56 offen
    s_add_u32 s56, s56, 8192
    s_waitcnt vmcnt(7)
    buffer_load_dwordx4 v[60:63], v4, s[40:43], s56 offen
    s_add_u32 s56, s56, 8192
    s_waitcnt vmcnt(7)
    s_sub_u32 s57, s57, 1
    s_cmp_lg_u32 s57, 0
    s_cbranch_scc1 WM_69
    s_and_b32 s52, s2, 7
    s_bfe_u32 s53, s2, 0x20003
    s_lshl2_add_u32 s52, s52, s53
    v_and_b32 v1, 7, v0
    s_lshl_b32 s52, s52, 10
    s_add_u32 s52, s52, 13697024
    v_lshl_add_u32 v1, v1, 7, s52
GW_70:
    buffer_load_dword v2, v1, s[4:7], 0 offen sc1
    s_waitcnt vmcnt(0)
    v_cmp_ne_u32 vcc, s49, v2
    s_cbranch_vccz GW_71
    s_sleep 8
    s_sub_u32 s48, s48, 1
    s_cbranch_scc0 GW_70
    s_mov_b32 s48, 0
GW_71:
    v_mov_b32 v2, 4
    ds_write_b32 v14, v2
M_g2:
    v_mov_b32 v4, v156
    v_mov_b32 v164, v157
    v_mov_b32 v5, v158
    v_mov_b32 v6, v159
    v_mov_b32 v162, v160
    v_mov_b32 v163, v161
    s_mov_b32 s58, s55
W_72:
    ds_read_b32 v2, v15
    s_waitcnt lgkmcnt(0)
    v_cmp_gt_u32 vcc, 4, v2
    s_cbranch_vccz W_73
    s_sub_u32 s48, s48, 1
    s_cbranch_scc0 W_72
    s_mov_b32 s48, 0
W_73:
    s_mov_b32 s44, s20
    s_mov_b32 s45, s21
    s_mov_b32 s46, 524288
    s_mov_b32 s47, 0x00020000
    s_setprio 0
    buffer_load_dword v9, v155, s[4:7], 0 offen sc1
    s_xor_b32 s53, s68, 128
    buffer_load_dword v11, v10, s[4:7], s68 offen sc1
    buffer_load_dword v12, v10, s[4:7], s53 offen sc1
    s_add_u32 m0, s58, 0
    s_add_u32 s52, s60, 65536
    buffer_load_dwordx4 v4, s[8:11], s60 offen lds
    buffer_load_dwordx4 v164, s[8:11], s60 offen offset:1024 lds
    s_cmp_eq_u32 s52, s62
    s_cselect_b32 s60, s61, s52
    s_add_u32 m0, s58, 2048
    s_add_u32 s52, s60, 65536
    buffer_load_dwordx4 v4, s[8:11], s60 offen lds
    buffer_load_dwordx4 v164, s[8:11], s60 offen offset:1024 lds
    s_cmp_eq_u32 s52, s62
    s_cselect_b32 s60, s61, s52
    s_add_u32 m0, s58, 4096
    s_add_u32 s52, s60, 65536
    buffer_load_dwordx4 v4, s[8:11], s60 offen lds
    buffer_load_dwordx4 v164, s[8:11], s60 offen offset:1024 lds
    s_cmp_eq_u32 s52, s62
    s_cselect_b32 s60, s61, s52
    s_waitcnt vmcnt(8)
    v_cmp_ne_u32 vcc, s49, v9
    s_cbranch_vccnz UW_74
    s_setprio 0
    buffer_load_dwordx4 v[32:35], v162, s[4:7], s63 offen sc1
    s_add_u32 s53, s63, 1024
    buffer_load_dwordx4 v[36:39], v163, s[4:7], s63 offen sc1
    s_cmp_eq_u32 s53, s73
    s_cselect_b32 s63, s71, s53
    buffer_load_dwordx4 v[40:43], v162, s[4:7], s63 offen sc1
    s_add_u32 s53, s63, 1024
    buffer_load_dwordx4 v[44:47], v163, s[4:7], s63 offen sc1
    s_cmp_eq_u32 s53, s73
    s_cselect_b32 s63, s71, s53
    buffer_load_dwordx4 v[48:51], v162, s[4:7], s63 offen sc1
    s_add_u32 s53, s63, 1024
    buffer_load_dwordx4 v[52:55], v163, s[4:7], s63 offen sc1
    s_cmp_eq_u32 s53, s73
    s_cselect_b32 s63, s71, s53
    s_add_u32 m0, s58, 6144
    s_add_u32 s52, s60, 65536
    buffer_load_dwordx4 v4, s[8:11], s60 offen lds
    buffer_load_dwordx4 v164, s[8:11], s60 offen offset:1024 lds
    s_cmp_eq_u32 s52, s62
    s_cselect_b32 s60, s61, s52
    buffer_load_dwordx4 v[56:59], v162, s[4:7], s63 offen sc1
    s_add_u32 s53, s63, 1024
    buffer_load_dwordx4 v[60:63], v163, s[4:7], s63 offen sc1
    s_cmp_eq_u32 s53, s73
    s_cselect_b32 s63, s71, s53
    s_add_u32 m0, s58, 8192
    s_add_u32 s52, s60, 65536
    buffer_load_dwordx4 v4, s[8:11], s60 offen lds
    buffer_load_dwordx4 v164, s[8:11], s60 offen offset:1024 lds
    s_cmp_eq_u32 s52, s62
    s_cselect_b32 s60, s61, s52
    buffer_load_dwordx4 v[64:67], v162, s[4:7], s63 offen sc1
    s_add_u32 s53, s63, 1024
    buffer_load_dwordx4 v[68:71], v163, s[4:7], s63 offen sc1
    s_cmp_eq_u32 s53, s73
    s_cselect_b32 s63, s71, s53
    s_add_u32 m0, s58, 10240
    s_add_u32 s52, s60, 65536
    buffer_load_dwordx4 v4, s[8:11], s60 offen lds
    buffer_load_dwordx4 v164, s[8:11], s60 offen offset:1024 lds
    s_cmp_eq_u32 s52, s62
    s_cselect_b32 s60, s61, s52
    buffer_load_dwordx4 v[72:75], v162, s[4:7], s63 offen sc1
    s_add_u32 s53, s63, 1024
    buffer_load_dwordx4 v[76:79], v163, s[4:7], s63 offen sc1
    s_cmp_eq_u32 s53, s73
    s_cselect_b32 s63, s71, s53
    s_add_u32 m0, s58, 12288
    s_add_u32 s52, s60, 65536
    buffer_load_dwordx4 v4, s[8:11], s60 offen lds
    buffer_load_dwordx4 v164, s[8:11], s60 offen offset:1024 lds
    s_cmp_eq_u32 s52, s62
    s_cselect_b32 s60, s61, s52
    s_add_u32 m0, s58, 14336
    s_add_u32 s52, s60, 65536
    buffer_load_dwordx4 v4, s[8:11], s60 offen lds
    buffer_load_dwordx4 v164, s[8:11], s60 offen offset:1024 lds
    s_cmp_eq_u32 s52, s62
    s_cselect_b32 s60, s61, s52
UW_75:
    s_waitcnt vmcnt(20)
    ds_read_b64_tr_b16 v[16:17], v5 offset:0
    ds_read_b64_tr_b16 v[18:19], v5 offset:1024
    ds_read_b64_tr_b16 v[20:21], v6 offset:0
    ds_read_b64_tr_b16 v[22:23], v6 offset:1024
    v_sub_f32 v156, 1.0, v11
    v_sub_f32 v158, 1.0, v12
    v_lshlrev_b32 v160, 16, v13
    v_mov_b32 v157, v156
    v_mov_b32 v159, v158
    v_mul_f32 v160, v160, v156
    v_mov_b32 v161, v160
    s_waitcnt lgkmcnt(0)
    v_mfma_f32_32x32x16_bf16 v[88:103], v[32:35], v[16:19], 0
    s_waitcnt vmcnt(18)
    ds_read_b64_tr_b16 v[24:25], v5 offset:2048
    ds_read_b64_tr_b16 v[26:27], v5 offset:3072
    ds_read_b64_tr_b16 v[28:29], v6 offset:2048
    ds_read_b64_tr_b16 v[30:31], v6 offset:3072
    v_mfma_f32_32x32x16_bf16 v[104:119], v[32:35], v[20:23], 0
    s_add_u32 m0, s58, 16384
    s_add_u32 s52, s60, 65536
    buffer_load_dwordx4 v4, s[8:11], s60 offen lds
    v_mfma_f32_32x32x16_bf16 v[120:135], v[36:39], v[16:19], 0
    buffer_load_dwordx4 v164, s[8:11], s60 offen offset:1024 lds
    s_cmp_eq_u32 s52, s62
    s_cselect_b32 s60, s61, s52
    buffer_load_dwordx4 v[80:83], v162, s[4:7], s63 offen sc1
    s_add_u32 s53, s63, 1024
    v_mfma_f32_32x32x16_bf16 v[136:151], v[36:39], v[20:23], 0
    buffer_load_dwordx4 v[84:87], v163, s[4:7], s63 offen sc1
    s_cmp_eq_u32 s53, s73
    s_cselect_b32 s63, s71, s53
    s_waitcnt lgkmcnt(0)
    v_mfma_f32_32x32x16_bf16 v[88:103], v[40:43], v[24:27], v[88:103]
    s_waitcnt vmcnt(20)
    ds_read_b64_tr_b16 v[16:17], v5 offset:4096
    ds_read_b64_tr_b16 v[18:19], v5 offset:5120
    ds_read_b64_tr_b16 v[20:21], v6 offset:4096
    ds_read_b64_tr_b16 v[22:23], v6 offset:5120
    v_mfma_f32_32x32x16_bf16 v[104:119], v[40:43], v[28:31], v[104:119]
    s_add_u32 m0, s58, 0
    s_add_u32 s52, s60, 65536
    buffer_load_dwordx4 v4, s[8:11], s60 offen lds
    v_mfma_f32_32x32x16_bf16 v[120:135], v[44:47], v[24:27], v[120:135]
    buffer_load_dwordx4 v164, s[8:11], s60 offen offset:1024 lds
    s_cmp_eq_u32 s52, s62
    s_cselect_b32 s60, s61, s52
    buffer_load_dwordx4 v[32:35], v162, s[4:7], s63 offen sc1
    s_add_u32 s53, s63, 1024
    v_mfma_f32_32x32x16_bf16 v[136:151], v[44:47], v[28:31], v[136:151]
    buffer_load_dwordx4 v[36:39], v163, s[4:7], s63 offen sc1
    s_cmp_eq_u32 s53, s73
    s_cselect_b32 s63, s71, s53
    s_waitcnt lgkmcnt(0)
    v_mfma_f32_32x32x16_bf16 v[88:103], v[48:51], v[16:19], v[88:103]
    s_waitcnt vmcnt(20)
    ds_read_b64_tr_b16 v[24:25], v5 offset:6144
    ds_read_b64_tr_b16 v[26:27], v5 offset:7168
    ds_read_b64_tr_b16 v[28:29], v6 offset:6144
    ds_read_b64_tr_b16 v[30:31], v6 offset:7168
    v_mfma_f32_32x32x16_bf16 v[104:119], v[48:51], v[20:23], v[104:119]
    s_add_u32 m0, s58, 2048
    s_add_u32 s52, s60, 65536
    buffer_load_dwordx4 v4, s[8:11], s60 offen lds
    v_mfma_f32_32x32x16_bf16 v[120:135], v[52:55], v[16:19], v[120:135]
    buffer_load_dwordx4 v164, s[8:11], s60 offen offset:1024 lds
    s_cmp_eq_u32 s52, s62
    s_cselect_b32 s60, s61, s52
    buffer_load_dwordx4 v[40:43], v162, s[4:7], s63 offen sc1
    s_add_u32 s53, s63, 1024
    v_mfma_f32_32x32x16_bf16 v[136:151], v[52:55], v[20:23], v[136:151]
    buffer_load_dwordx4 v[44:47], v163, s[4:7], s63 offen sc1
    s_cmp_eq_u32 s53, s73
    s_cselect_b32 s63, s71, s53
    s_waitcnt lgkmcnt(0)
    v_mfma_f32_32x32x16_bf16 v[88:103], v[56:59], v[24:27], v[88:103]
    s_waitcnt vmcnt(20)
    ds_read_b64_tr_b16 v[16:17], v5 offset:8192
    ds_read_b64_tr_b16 v[18:19], v5 offset:9216
    ds_read_b64_tr_b16 v[20:21], v6 offset:8192
    ds_read_b64_tr_b16 v[22:23], v6 offset:9216
    v_mfma_f32_32x32x16_bf16 v[104:119], v[56:59], v[28:31], v[104:119]
    s_add_u32 m0, s58, 4096
    s_add_u32 s52, s60, 65536
    buffer_load_dwordx4 v4, s[8:11], s60 offen lds
    v_mfma_f32_32x32x16_bf16 v[120:135], v[60:63], v[24:27], v[120:135]
    buffer_load_dwordx4 v164, s[8:11], s60 offen offset:1024 lds
    s_cmp_eq_u32 s52, s62
    s_cselect_b32 s60, s61, s52
    buffer_load_dwordx4 v[48:51], v162, s[4:7], s63 offen sc1
    s_add_u32 s53, s63, 1024
    v_mfma_f32_32x32x16_bf16 v[136:151], v[60:63], v[28:31], v[136:151]
    buffer_load_dwordx4 v[52:55], v163, s[4:7], s63 offen sc1
    s_cmp_eq_u32 s53, s73
    s_cselect_b32 s63, s71, s53
    s_waitcnt lgkmcnt(0)
    v_mfma_f32_32x32x16_bf16 v[88:103], v[64:67], v[16:19], v[88:103]
    s_waitcnt vmcnt(20)
    ds_read_b64_tr_b16 v[24:25], v5 offset:10240
    ds_read_b64_tr_b16 v[26:27], v5 offset:11264
    ds_read_b64_tr_b16 v[28:29], v6 offset:10240
    ds_read_b64_tr_b16 v[30:31], v6 offset:11264
    v_mfma_f32_32x32x16_bf16 v[104:119], v[64:67], v[20:23], v[104:119]
    s_add_u32 m0, s58, 6144
    s_add_u32 s52, s60, 65536
    buffer_load_dwordx4 v4, s[8:11], s60 offen lds
    v_mfma_f32_32x32x16_bf16 v[120:135], v[68:71], v[16:19], v[120:135]
    buffer_load_dwordx4 v164, s[8:11], s60 offen offset:1024 lds
    s_cmp_eq_u32 s52, s62
    s_cselect_b32 s60, s61, s52
    buffer_load_dwordx4 v[56:59], v162, s[4:7], s63 offen sc1
    s_add_u32 s53, s63, 1024
    v_mfma_f32_32x32x16_bf16 v[136:151], v[68:71], v[20:23], v[136:151]
    buffer_load_dwordx4 v[60:63], v163, s[4:7], s63 offen sc1
    s_cmp_eq_u32 s53, s73
    s_cselect_b32 s63, s71, s53
    s_waitcnt lgkmcnt(0)
    v_mfma_f32_32x32x16_bf16 v[88:103], v[72:75], v[24:27], v[88:103]
    s_waitcnt vmcnt(16)
    ds_read_b64_tr_b16 v[16:17], v5 offset:12288
    ds_read_b64_tr_b16 v[18:19], v5 offset:13312
    ds_read_b64_tr_b16 v[20:21], v6 offset:12288
    ds_read_b64_tr_b16 v[22:23], v6 offset:13312
    v_mfma_f32_32x32x16_bf16 v[104:119], v[72:75], v[28:31], v[104:119]
    s_add_u32 m0, s58, 8192
    s_add_u32 s52, s60, 65536
    buffer_load_dwordx4 v4, s[8:11], s60 offen lds
    v_mfma_f32_32x32x16_bf16 v[120:135], v[76:79], v[24:27], v[120:135]
    buffer_load_dwordx4 v164, s[8:11], s60 offen offset:1024 lds
    s_cmp_eq_u32 s52, s62
    s_cselect_b32 s60, s61, s52
    buffer_load_dwordx4 v[64:67], v162, s[4:7], s63 offen sc1
    s_add_u32 s53, s63, 1024
    v_mfma_f32_32x32x16_bf16 v[136:151], v[76:79], v[28:31], v[136:151]
    buffer_load_dwordx4 v[68:71], v163, s[4:7], s63 offen sc1
    s_cmp_eq_u32 s53, s73
    s_cselect_b32 s63, s71, s53
    s_waitcnt lgkmcnt(0)
    v_mfma_f32_32x32x16_bf16 v[88:103], v[80:83], v[16:19], v[88:103]
    s_waitcnt vmcnt(16)
    ds_read_b64_tr_b16 v[24:25], v5 offset:14336
    ds_read_b64_tr_b16 v[26:27], v5 offset:15360
    ds_read_b64_tr_b16 v[28:29], v6 offset:14336
    ds_read_b64_tr_b16 v[30:31], v6 offset:15360
    v_mfma_f32_32x32x16_bf16 v[104:119], v[80:83], v[20:23], v[104:119]
    s_add_u32 m0, s58, 10240
    s_add_u32 s52, s60, 65536
    buffer_load_dwordx4 v4, s[8:11], s60 offen lds
    v_mfma_f32_32x32x16_bf16 v[120:135], v[84:87], v[16:19], v[120:135]
    buffer_load_dwordx4 v164, s[8:11], s60 offen offset:1024 lds
    s_cmp_eq_u32 s52, s62
    s_cselect_b32 s60, s61, s52
    buffer_load_dwordx4 v[72:75], v162, s[4:7], s63 offen sc1
    s_add_u32 s53, s63, 1024
    v_mfma_f32_32x32x16_bf16 v[136:151], v[84:87], v[20:23], v[136:151]
    buffer_load_dwordx4 v[76:79], v163, s[4:7], s63 offen sc1
    s_cmp_eq_u32 s53, s73
    s_cselect_b32 s63, s71, s53
    s_waitcnt lgkmcnt(0)
    v_mfma_f32_32x32x16_bf16 v[88:103], v[32:35], v[24:27], v[88:103]
    s_waitcnt vmcnt(16)
    ds_read_b64_tr_b16 v[16:17], v5 offset:16384
    ds_read_b64_tr_b16 v[18:19], v5 offset:17408
    ds_read_b64_tr_b16 v[20:21], v6 offset:16384
    ds_read_b64_tr_b16 v[22:23], v6 offset:17408
    v_mfma_f32_32x32x16_bf16 v[104:119], v[32:35], v[28:31], v[104:119]
    s_add_u32 m0, s58, 12288
    s_add_u32 s52, s60, 65536
    buffer_load_dwordx4 v4, s[8:11], s60 offen lds
    v_mfma_f32_32x32x16_bf16 v[120:135], v[36:39], v[24:27], v[120:135]
    buffer_load_dwordx4 v164, s[8:11], s60 offen offset:1024 lds
    s_cmp_eq_u32 s52, s62
    s_cselect_b32 s60, s61, s52
    buffer_load_dwordx4 v[80:83], v162, s[4:7], s63 offen sc1
    s_add_u32 s53, s63, 1024
    v_mfma_f32_32x32x16_bf16 v[136:151], v[36:39], v[28:31], v[136:151]
    buffer_load_dwordx4 v[84:87], v163, s[4:7], s63 offen sc1
    s_cmp_eq_u32 s53, s73
    s_cselect_b32 s63, s71, s53
    s_waitcnt lgkmcnt(0)
    v_mfma_f32_32x32x16_bf16 v[88:103], v[40:43], v[16:19], v[88:103]
    s_waitcnt vmcnt(16)
    ds_read_b64_tr_b16 v[24:25], v5 offset:0
    ds_read_b64_tr_b16 v[26:27], v5 offset:1024
    ds_read_b64_tr_b16 v[28:29], v6 offset:0
    ds_read_b64_tr_b16 v[30:31], v6 offset:1024
    v_mfma_f32_32x32x16_bf16 v[104:119], v[40:43], v[20:23], v[104:119]
    s_add_u32 m0, s58, 14336
    s_add_u32 s52, s60, 65536
    buffer_load_dwordx4 v4, s[8:11], s60 offen lds
    v_mfma_f32_32x32x16_bf16 v[120:135], v[44:47], v[16:19], v[120:135]
    buffer_load_dwordx4 v164, s[8:11], s60 offen offset:1024 lds
    s_cmp_eq_u32 s52, s62
    s_cselect_b32 s60, s61, s52
    buffer_load_dwordx4 v[32:35], v162, s[4:7], s63 offen sc1
    s_add_u32 s53, s63, 1024
    v_mfma_f32_32x32x16_bf16 v[136:151], v[44:47], v[20:23], v[136:151]
    buffer_load_dwordx4 v[36:39], v163, s[4:7], s63 offen sc1
    s_cmp_eq_u32 s53, s73
    s_cselect_b32 s63, s71, s53
    s_waitcnt lgkmcnt(0)
    v_mfma_f32_32x32x16_bf16 v[88:103], v[48:51], v[24:27], v[88:103]
    s_waitcnt vmcnt(16)
    ds_read_b64_tr_b16 v[16:17], v5 offset:2048
    ds_read_b64_tr_b16 v[18:19], v5 offset:3072
    ds_read_b64_tr_b16 v[20:21], v6 offset:2048
    ds_read_b64_tr_b16 v[22:23], v6 offset:3072
    v_mfma_f32_32x32x16_bf16 v[104:119], v[48:51], v[28:31], v[104:119]
    s_add_u32 m0, s58, 16384
    s_add_u32 s52, s60, 65536
    buffer_load_dwordx4 v4, s[8:11], s60 offen lds
    v_mfma_f32_32x32x16_bf16 v[120:135], v[52:55], v[24:27], v[120:135]
    buffer_load_dwordx4 v164, s[8:11], s60 offen offset:1024 lds
    s_cmp_eq_u32 s52, s62
    s_cselect_b32 s60, s61, s52
    buffer_load_dwordx4 v[40:43], v162, s[4:7], s63 offen sc1
    s_add_u32 s53, s63, 1024
    v_mfma_f32_32x32x16_bf16 v[136:151], v[52:55], v[28:31], v[136:151]
    buffer_load_dwordx4 v[44:47], v163, s[4:7], s63 offen sc1
    s_cmp_eq_u32 s53, s73
    s_cselect_b32 s63, s71, s53
    s_waitcnt lgkmcnt(0)
    v_mfma_f32_32x32x16_bf16 v[88:103], v[56:59], v[16:19], v[88:103]
    s_waitcnt vmcnt(16)
    ds_read_b64_tr_b16 v[24:25], v5 offset:4096
    ds_read_b64_tr_b16 v[26:27], v5 offset:5120
    ds_read_b64_tr_b16 v[28:29], v6 offset:4096
    ds_read_b64_tr_b16 v[30:31], v6 offset:5120
    v_mfma_f32_32x32x16_bf16 v[104:119], v[56:59], v[20:23], v[104:119]
    s_add_u32 m0, s58, 0
    s_add_u32 s52, s60, 65536
    buffer_load_dwordx4 v4, s[8:11], s60 offen lds
    v_mfma_f32_32x32x16_bf16 v[120:135], v[60:63], v[16:19], v[120:135]
    buffer_load_dwordx4 v164, s[8:11], s60 offen offset:1024 lds
    s_cmp_eq_u32 s52, s62
    s_cselect_b32 s60, s61, s52
    buffer_load_dwordx4 v[48:51], v162, s[4:7], s63 offen sc1
    s_add_u32 s53, s63, 1024
    v_mfma_f32_32x32x16_bf16 v[136:151], v[60:63], v[20:23], v[136:151]
    buffer_load_dwordx4 v[52:55], v163, s[4:7], s63 offen sc1
    s_cmp_eq_u32 s53, s73
    s_cselect_b32 s63, s71, s53
    s_waitcnt lgkmcnt(0)
    v_mfma_f32_32x32x16_bf16 v[88:103], v[64:67], v[24:27], v[88:103]
    s_waitcnt vmcnt(16)
    ds_read_b64_tr_b16 v[16:17], v5 offset:6144
    ds_read_b64_tr_b16 v[18:19], v5 offset:7168
    ds_read_b64_tr_b16 v[20:21], v6 offset:6144
    ds_read_b64_tr_b16 v[22:23], v6 offset:7168
    v_mfma_f32_32x32x16_bf16 v[104:119], v[64:67], v[28:31], v[104:119]
    s_add_u32 m0, s58, 2048
    s_add_u32 s52, s60, 65536
    buffer_load_dwordx4 v4, s[8:11], s60 offen lds
    v_mfma_f32_32x32x16_bf16 v[120:135], v[68:71], v[24:27], v[120:135]
    buffer_load_dwordx4 v164, s[8:11], s60 offen offset:1024 lds
    s_cmp_eq_u32 s52, s62
    s_cselect_b32 s60, s61, s52
    buffer_load_dwordx4 v[56:59], v162, s[4:7], s63 offen sc1
    s_add_u32 s53, s63, 1024
    v_mfma_f32_32x32x16_bf16 v[136:151], v[68:71], v[28:31], v[136:151]
    buffer_load_dwordx4 v[60:63], v163, s[4:7], s63 offen sc1
    s_cmp_eq_u32 s53, s73
    s_cselect_b32 s63, s71, s53
    s_waitcnt lgkmcnt(0)
    v_mfma_f32_32x32x16_bf16 v[88:103], v[72:75], v[16:19], v[88:103]
    s_waitcnt vmcnt(16)
    ds_read_b64_tr_b16 v[24:25], v5 offset:8192
    ds_read_b64_tr_b16 v[26:27], v5 offset:9216
    ds_read_b64_tr_b16 v[28:29], v6 offset:8192
    ds_read_b64_tr_b16 v[30:31], v6 offset:9216
    v_mfma_f32_32x32x16_bf16 v[104:119], v[72:75], v[20:23], v[104:119]
    s_add_u32 m0, s58, 4096
    s_add_u32 s52, s60, 65536
    buffer_load_dwordx4 v4, s[8:11], s60 offen lds
    v_mfma_f32_32x32x16_bf16 v[120:135], v[76:79], v[16:19], v[120:135]
    buffer_load_dwordx4 v164, s[8:11], s60 offen offset:1024 lds
    s_cmp_eq_u32 s52, s62
    s_cselect_b32 s60, s61, s52
    buffer_load_dwordx4 v[64:67], v162, s[4:7], s63 offen sc1
    s_add_u32 s53, s63, 1024
    v_mfma_f32_32x32x16_bf16 v[136:151], v[76:79], v[20:23], v[136:151]
    buffer_load_dwordx4 v[68:71], v163, s[4:7], s63 offen sc1
    s_cmp_eq_u32 s53, s73
    s_cselect_b32 s63, s71, s53
    s_waitcnt lgkmcnt(0)
    v_mfma_f32_32x32x16_bf16 v[88:103], v[80:83], v[24:27], v[88:103]
    s_waitcnt vmcnt(16)
    ds_read_b64_tr_b16 v[16:17], v5 offset:10240
    ds_read_b64_tr_b16 v[18:19], v5 offset:11264
    ds_read_b64_tr_b16 v[20:21], v6 offset:10240
    ds_read_b64_tr_b16 v[22:23], v6 offset:11264
    v_mfma_f32_32x32x16_bf16 v[104:119], v[80:83], v[28:31], v[104:119]
    s_add_u32 m0, s58, 6144
    s_add_u32 s52, s60, 65536
    buffer_load_dwordx4 v4, s[8:11], s60 offen lds
    v_mfma_f32_32x32x16_bf16 v[120:135], v[84:87], v[24:27], v[120:135]
    buffer_load_dwordx4 v164, s[8:11], s60 offen offset:1024 lds
    s_cmp_eq_u32 s52, s62
    s_cselect_b32 s60, s61, s52
    buffer_load_dwordx4 v[72:75], v162, s[4:7], s63 offen sc1
    s_add_u32 s53, s63, 1024
    v_mfma_f32_32x32x16_bf16 v[136:151], v[84:87], v[28:31], v[136:151]
    buffer_load_dwordx4 v[76:79], v163, s[4:7], s63 offen sc1
    s_cmp_eq_u32 s53, s73
    s_cselect_b32 s63, s71, s53
    s_waitcnt lgkmcnt(0)
    v_mfma_f32_32x32x16_bf16 v[88:103], v[32:35], v[16:19], v[88:103]
    s_waitcnt vmcnt(16)
    ds_read_b64_tr_b16 v[24:25], v5 offset:12288
    ds_read_b64_tr_b16 v[26:27], v5 offset:13312
    ds_read_b64_tr_b16 v[28:29], v6 offset:12288
    ds_read_b64_tr_b16 v[30:31], v6 offset:13312
    v_mfma_f32_32x32x16_bf16 v[104:119], v[32:35], v[20:23], v[104:119]
    s_add_u32 m0, s58, 8192
    s_add_u32 s52, s60, 65536
    buffer_load_dwordx4 v4, s[8:11], s60 offen lds
    v_mfma_f32_32x32x16_bf16 v[120:135], v[36:39], v[16:19], v[120:135]
    buffer_load_dwordx4 v164, s[8:11], s60 offen offset:1024 lds
    s_cmp_eq_u32 s52, s62
    s_cselect_b32 s60, s61, s52
    buffer_load_dwordx4 v[80:83], v162, s[4:7], s63 offen sc1
    s_add_u32 s53, s63, 1024
    v_mfma_f32_32x32x16_bf16 v[136:151], v[36:39], v[20:23], v[136:151]
    buffer_load_dwordx4 v[84:87], v163, s[4:7], s63 offen sc1
    s_cmp_eq_u32 s53, s73
    s_cselect_b32 s63, s71, s53
    s_waitcnt lgkmcnt(0)
    v_mfma_f32_32x32x16_bf16 v[88:103], v[40:43], v[24:27], v[88:103]
    s_waitcnt vmcnt(16)
    ds_read_b64_tr_b16 v[16:17], v5 offset:14336
    ds_read_b64_tr_b16 v[18:19], v5 offset:15360
    ds_read_b64_tr_b16 v[20:21], v6 offset:14336
    ds_read_b64_tr_b16 v[22:23], v6 offset:15360
    v_mfma_f32_32x32x16_bf16 v[104:119], v[40:43], v[28:31], v[104:119]
    s_add_u32 m0, s58, 10240
    s_add_u32 s52, s60, 65536
    buffer_load_dwordx4 v4, s[8:11], s60 offen lds
    v_mfma_f32_32x32x16_bf16 v[120:135], v[44:47], v[24:27], v[120:135]
    buffer_load_dwordx4 v164, s[8:11], s60 offen offset:1024 lds
    s_cmp_eq_u32 s52, s62
    s_cselect_b32 s60, s61, s52
    buffer_load_dwordx4 v[32:35], v162, s[4:7], s63 offen sc1
    s_add_u32 s53, s63, 1024
    v_mfma_f32_32x32x16_bf16 v[136:151], v[44:47], v[28:31], v[136:151]
    buffer_load_dwordx4 v[36:39], v163, s[4:7], s63 offen sc1
    s_cmp_eq_u32 s53, s73
    s_cselect_b32 s63, s71, s53
    s_waitcnt lgkmcnt(0)
    v_mfma_f32_32x32x16_bf16 v[88:103], v[48:51], v[16:19], v[88:103]
    s_waitcnt vmcnt(16)
    ds_read_b64_tr_b16 v[24:25], v5 offset:16384
    ds_read_b64_tr_b16 v[26:27], v5 offset:17408
    ds_read_b64_tr_b16 v[28:29], v6 offset:16384
    ds_read_b64_tr_b16 v[30:31], v6 offset:17408
    v_mfma_f32_32x32x16_bf16 v[104:119], v[48:51], v[20:23], v[104:119]
    s_add_u32 m0, s58, 12288
    s_add_u32 s52, s60, 65536
    buffer_load_dwordx4 v4, s[8:11], s60 offen lds
    v_mfma_f32_32x32x16_bf16 v[120:135], v[52:55], v[16:19], v[120:135]
    buffer_load_dwordx4 v164, s[8:11], s60 offen offset:1024 lds
    s_cmp_eq_u32 s52, s62
    s_cselect_b32 s60, s61, s52
    buffer_load_dwordx4 v[40:43], v162, s[4:7], s63 offen sc1
    s_add_u32 s53, s63, 1024
    v_mfma_f32_32x32x16_bf16 v[136:151], v[52:55], v[20:23], v[136:151]
    buffer_load_dwordx4 v[44:47], v163, s[4:7], s63 offen sc1
    s_cmp_eq_u32 s53, s73
    s_cselect_b32 s63, s71, s53
    s_waitcnt lgkmcnt(0)
    v_mfma_f32_32x32x16_bf16 v[88:103], v[56:59], v[24:27], v[88:103]
    s_waitcnt vmcnt(16)
    ds_read_b64_tr_b16 v[16:17], v5 offset:0
    ds_read_b64_tr_b16 v[18:19], v5 offset:1024
    ds_read_b64_tr_b16 v[20:21], v6 offset:0
    ds_read_b64_tr_b16 v[22:23], v6 offset:1024
    v_mfma_f32_32x32x16_bf16 v[104:119], v[56:59], v[28:31], v[104:119]
    s_add_u32 m0, s58, 14336
    s_add_u32 s52, s60, 65536
    buffer_load_dwordx4 v4, s[8:11], s60 offen lds
    v_mfma_f32_32x32x16_bf16 v[120:135], v[60:63], v[24:27], v[120:135]
    buffer_load_dwordx4 v164, s[8:11], s60 offen offset:1024 lds
    s_cmp_eq_u32 s52, s62
    s_cselect_b32 s60, s61, s52
    buffer_load_dwordx4 v[48:51], v162, s[4:7], s63 offen sc1
    s_add_u32 s53, s63, 1024
    v_mfma_f32_32x32x16_bf16 v[136:151], v[60:63], v[28:31], v[136:151]
    buffer_load_dwordx4 v[52:55], v163, s[4:7], s63 offen sc1
    s_cmp_eq_u32 s53, s73
    s_cselect_b32 s63, s71, s53
    buffer_load_dword v155, v154, s[4:7], 0 offen sc1
    s_waitcnt lgkmcnt(0)
    v_mfma_f32_32x32x16_bf16 v[88:103], v[64:67], v[16:19], v[88:103]
    s_waitcnt vmcnt(17)
    ds_read_b64_tr_b16 v[24:25], v5 offset:2048
    ds_read_b64_tr_b16 v[26:27], v5 offset:3072
    ds_read_b64_tr_b16 v[28:29], v6 offset:2048
    ds_read_b64_tr_b16 v[30:31], v6 offset:3072
    v_mfma_f32_32x32x16_bf16 v[104:119], v[64:67], v[20:23], v[104:119]
    s_add_u32 m0, s58, 16384
    s_add_u32 s52, s60, 65536
    buffer_load_dwordx4 v4, s[8:11], s60 offen lds
    v_mfma_f32_32x32x16_bf16 v[120:135], v[68:71], v[16:19], v[120:135]
    buffer_load_dwordx4 v164, s[8:11], s60 offen offset:1024 lds
    s_cmp_eq_u32 s52, s62
    s_cselect_b32 s60, s61, s52
    buffer_load_dwordx4 v[56:59], v162, s[4:7], s63 offen sc1
    s_add_u32 s53, s63, 1024
    v_mfma_f32_32x32x16_bf16 v[136:151], v[68:71], v[20:23], v[136:151]
    buffer_load_dwordx4 v[60:63], v163, s[4:7], s63 offen sc1
    s_cmp_eq_u32 s53, s73
    s_cselect_b32 s63, s71, s53
    s_waitcnt lgkmcnt(0)
    v_mfma_f32_32x32x16_bf16 v[88:103], v[72:75], v[24:27], v[88:103]
    s_waitcnt vmcnt(17)
    ds_read_b64_tr_b16 v[16:17], v5 offset:4096
    ds_read_b64_tr_b16 v[18:19], v5 offset:5120
    ds_read_b64_tr_b16 v[20:21], v6 offset:4096
    ds_read_b64_tr_b16 v[22:23], v6 offset:5120
    v_mfma_f32_32x32x16_bf16 v[104:119], v[72:75], v[28:31], v[104:119]
    s_add_u32 m0, s58, 0
    s_add_u32 s52, s60, 65536
    buffer_load_dwordx4 v4, s[8:11], s60 offen lds
    v_mfma_f32_32x32x16_bf16 v[120:135], v[76:79], v[24:27], v[120:135]
    buffer_load_dwordx4 v164, s[8:11], s60 offen offset:1024 lds
    s_cmp_eq_u32 s52, s62
    s_cselect_b32 s60, s61, s52
    buffer_load_dwordx4 v[64:67], v162, s[4:7], s63 offen sc1
    s_add_u32 s53, s63, 1024
    v_mfma_f32_32x32x16_bf16 v[136:151], v[76:79], v[28:31], v[136:151]
    buffer_load_dwordx4 v[68:71], v163, s[4:7], s63 offen sc1
    s_cmp_eq_u32 s53, s73
    s_cselect_b32 s63, s71, s53
    s_waitcnt lgkmcnt(0)
    v_mfma_f32_32x32x16_bf16 v[88:103], v[80:83], v[16:19], v[88:103]
    s_waitcnt vmcnt(17)
    ds_read_b64_tr_b16 v[24:25], v5 offset:6144
    ds_read_b64_tr_b16 v[26:27], v5 offset:7168
    ds_read_b64_tr_b16 v[28:29], v6 offset:6144
    ds_read_b64_tr_b16 v[30:31], v6 offset:7168
    v_mfma_f32_32x32x16_bf16 v[104:119], v[80:83], v[20:23], v[104:119]
    s_add_u32 m0, s58, 2048
    s_add_u32 s52, s67, s66
    buffer_load_dwordx4 v165, s[44:47], s52 offen lds
    v_mfma_f32_32x32x16_bf16 v[120:135], v[84:87], v[16:19], v[120:135]
    buffer_load_dwordx4 v166, s[44:47], s52 offen offset:1024 lds
    s_add_u32 s67, s67, 0x4000
    s_and_b32 s67, s67, 0x1ffff
    buffer_load_dwordx4 v[72:75], v162, s[4:7], s63 offen sc1
    s_add_u32 s53, s63, 1024
    v_mfma_f32_32x32x16_bf16 v[136:151], v[84:87], v[20:23], v[136:151]
    buffer_load_dwordx4 v[76:79], v163, s[4:7], s63 offen sc1
    s_cmp_eq_u32 s53, s73
    s_cselect_b32 s63, s71, s53
    s_waitcnt lgkmcnt(0)
    v_mfma_f32_32x32x16_bf16 v[88:103], v[32:35], v[24:27], v[88:103]
    s_waitcnt vmcnt(17)
    ds_read_b64_tr_b16 v[16:17], v5 offset:8192
    ds_read_b64_tr_b16 v[18:19], v5 offset:9216
    ds_read_b64_tr_b16 v[20:21], v6 offset:8192
    ds_read_b64_tr_b16 v[22:23], v6 offset:9216
    v_mfma_f32_32x32x16_bf16 v[104:119], v[32:35], v[28:31], v[104:119]
    s_add_u32 m0, s58, 4096
    s_add_u32 s52, s67, s66
    buffer_load_dwordx4 v165, s[44:47], s52 offen lds
    v_mfma_f32_32x32x16_bf16 v[120:135], v[36:39], v[24:27], v[120:135]
    buffer_load_dwordx4 v166, s[44:47], s52 offen offset:1024 lds
    s_add_u32 s67, s67, 0x4000
    s_and_b32 s67, s67, 0x1ffff
    buffer_load_dwordx4 v[80:83], v162, s[4:7], s63 offen sc1
    s_add_u32 s53, s63, 1024
    v_mfma_f32_32x32x16_bf16 v[136:151], v[36:39], v[28:31], v[136:151]
    buffer_load_dwordx4 v[84:87], v163, s[4:7], s63 offen sc1
    s_cmp_eq_u32 s53, s73
    s_cselect_b32 s63, s71, s53
    s_waitcnt vmcnt(16)
    v_cmp_ne_u32 vcc, s49, v155
    s_cbranch_vccnz OS_94
OJ_95:
    s_waitcnt lgkmcnt(0)
    v_mfma_f32_32x32x16_bf16 v[88:103], v[40:43], v[16:19], v[88:103]
    s_waitcnt vmcnt(16)
    ds_read_b64_tr_b16 v[24:25], v5 offset:10240
    ds_read_b64_tr_b16 v[26:27], v5 offset:11264
    ds_read_b64_tr_b16 v[28:29], v6 offset:10240
    ds_read_b64_tr_b16 v[30:31], v6 offset:11264
    v_mfma_f32_32x32x16_bf16 v[104:119], v[40:43], v[20:23], v[104:119]
    s_add_u32 m0, s58, 6144
    s_add_u32 s52, s67, s66
    buffer_load_dwordx4 v165, s[44:47], s52 offen lds
    v_mfma_f32_32x32x16_bf16 v[120:135], v[44:47], v[16:19], v[120:135]
    buffer_load_dwordx4 v166, s[44:47], s52 offen offset:1024 lds
    s_add_u32 s67, s67, 0x4000
    s_and_b32 s67, s67, 0x1ffff
    buffer_load_dwordx4 v[32:35], v8, s[4:7], s69 offen offset:0 sc1
    v_mfma_f32_32x32x16_bf16 v[136:151], v[44:47], v[20:23], v[136:151]
    buffer_load_dwordx4 v[36:39], v167, s[4:7], s69 offen offset:0 sc1
    s_waitcnt lgkmcnt(0)
    v_mfma_f32_32x32x16_bf16 v[88:103], v[48:51], v[24:27], v[88:103]
    s_waitcnt vmcnt(16)
    ds_read_b64_tr_b16 v[16:17], v5 offset:12288
    ds_read_b64_tr_b16 v[18:19], v5 offset:13312
    ds_read_b64_tr_b16 v[20:21], v6 offset:12288
    ds_read_b64_tr_b16 v[22:23], v6 offset:13312
    v_mfma_f32_32x32x16_bf16 v[104:119], v[48:51], v[28:31], v[104:119]
    s_add_u32 m0, s58, 8192
    s_add_u32 s52, s67, s66
    buffer_load_dwordx4 v165, s[44:47], s52 offen lds
    v_mfma_f32_32x32x16_bf16 v[120:135], v[52:55], v[24:27], v[120:135]
    buffer_load_dwordx4 v166, s[44:47], s52 offen offset:1024 lds
    s_add_u32 s67, s67, 0x4000
    s_and_b32 s67, s67, 0x1ffff
    buffer_load_dwordx4 v[40:43], v8, s[4:7], s69 offen offset:1024 sc1
    v_mfma_f32_32x32x16_bf16 v[136:151], v[52:55], v[28:31], v[136:151]
    buffer_load_dwordx4 v[44:47], v167, s[4:7], s69 offen offset:1024 sc1
    s_waitcnt lgkmcnt(0)
    v_mfma_f32_32x32x16_bf16 v[88:103], v[56:59], v[16:19], v[88:103]
    s_waitcnt vmcnt(16)
    ds_read_b64_tr_b16 v[24:25], v5 offset:14336
    ds_read_b64_tr_b16 v[26:27], v5 offset:15360
    ds_read_b64_tr_b16 v[28:29], v6 offset:14336
    ds_read_b64_tr_b16 v[30:31], v6 offset:15360
    v_mfma_f32_32x32x16_bf16 v[104:119], v[56:59], v[20:23], v[104:119]
    s_add_u32 m0, s58, 10240
    s_add_u32 s52, s67, s66
    buffer_load_dwordx4 v165, s[44:47], s52 offen lds
    v_mfma_f32_32x32x16_bf16 v[120:135], v[60:63], v[16:19], v[120:135]
    buffer_load_dwordx4 v166, s[44:47], s52 offen offset:1024 lds
    s_add_u32 s67, s67, 0x4000
    s_and_b32 s67, s67, 0x1ffff
    buffer_load_dwordx4 v[48:51], v8, s[4:7], s69 offen offset:2048 sc1
    v_mfma_f32_32x32x16_bf16 v[136:151], v[60:63], v[20:23], v[136:151]
    buffer_load_dwordx4 v[52:55], v167, s[4:7], s69 offen offset:2048 sc1
    s_waitcnt lgkmcnt(0)
    v_mfma_f32_32x32x16_bf16 v[88:103], v[64:67], v[24:27], v[88:103]
    s_waitcnt vmcnt(16)
    ds_read_b64_tr_b16 v[16:17], v5 offset:16384
    ds_read_b64_tr_b16 v[18:19], v5 offset:17408
    ds_read_b64_tr_b16 v[20:21], v6 offset:16384
    ds_read_b64_tr_b16 v[22:23], v6 offset:17408
    v_mfma_f32_32x32x16_bf16 v[104:119], v[64:67], v[28:31], v[104:119]
    s_add_u32 m0, s58, 12288
    s_add_u32 s52, s67, s66
    buffer_load_dwordx4 v165, s[44:47], s52 offen lds
    v_mfma_f32_32x32x16_bf16 v[120:135], v[68:71], v[24:27], v[120:135]
    buffer_load_dwordx4 v166, s[44:47], s52 offen offset:1024 lds
    s_add_u32 s67, s67, 0x4000
    s_and_b32 s67, s67, 0x1ffff
    buffer_load_dwordx4 v[56:59], v8, s[4:7], s69 offen offset:3072 sc1
    v_mfma_f32_32x32x16_bf16 v[136:151], v[68:71], v[28:31], v[136:151]
    buffer_load_dwordx4 v[60:63], v167, s[4:7], s69 offen offset:3072 sc1
    s_waitcnt lgkmcnt(0)
    v_mfma_f32_32x32x16_bf16 v[88:103], v[72:75], v[16:19], v[88:103]
    s_waitcnt vmcnt(16)
    ds_read_b64_tr_b16 v[24:25], v5 offset:0
    ds_read_b64_tr_b16 v[26:27], v5 offset:1024
    ds_read_b64_tr_b16 v[28:29], v6 offset:0
    ds_read_b64_tr_b16 v[30:31], v6 offset:1024
    v_mfma_f32_32x32x16_bf16 v[104:119], v[72:75], v[20:23], v[104:119]
    s_add_u32 m0, s58, 14336
    s_add_u32 s52, s67, s66
    buffer_load_dwordx4 v165, s[44:47], s52 offen lds
    v_mfma_f32_32x32x16_bf16 v[120:135], v[76:79], v[16:19], v[120:135]
    buffer_load_dwordx4 v166, s[44:47], s52 offen offset:1024 lds
    s_add_u32 s67, s67, 0x4000
    s_and_b32 s67, s67, 0x1ffff
    buffer_load_dwordx4 v[64:67], v8, s[4:7], s70 offen offset:0 sc1
    v_mfma_f32_32x32x16_bf16 v[136:151], v[76:79], v[20:23], v[136:151]
    buffer_load_dwordx4 v[68:71], v167, s[4:7], s70 offen offset:0 sc1
    s_waitcnt lgkmcnt(0)
    v_mfma_f32_32x32x16_bf16 v[88:103], v[80:83], v[24:27], v[88:103]
    s_waitcnt vmcnt(16)
    ds_read_b64_tr_b16 v[16:17], v152 offset:2048
    ds_read_b64_tr_b16 v[18:19], v152 offset:3072
    ds_read_b64_tr_b16 v[20:21], v153 offset:2048
    ds_read_b64_tr_b16 v[22:23], v153 offset:3072
    v_mfma_f32_32x32x16_bf16 v[104:119], v[80:83], v[28:31], v[104:119]
    s_add_u32 m0, s58, 16384
    s_add_u32 s52, s67, s66
    buffer_load_dwordx4 v165, s[44:47], s52 offen lds
    v_mfma_f32_32x32x16_bf16 v[120:135], v[84:87], v[24:27], v[120:135]
    buffer_load_dwordx4 v166, s[44:47], s52 offen offset:1024 lds
    s_add_u32 s67, s67, 0x4000
    s_and_b32 s67, s67, 0x1ffff
    buffer_load_dwordx4 v[72:75], v8, s[4:7], s70 offen offset:1024 sc1
    v_mfma_f32_32x32x16_bf16 v[136:151], v[84:87], v[28:31], v[136:151]
    buffer_load_dwordx4 v[76:79], v167, s[4:7], s70 offen offset:1024 sc1
    s_setprio 3
    v_pk_fma_f32 v[88:89], v[88:89], v[156:157], v[160:161]
    v_pk_fma_f32 v[90:91], v[90:91], v[156:157], v[160:161]
    v_pk_fma_f32 v[92:93], v[92:93], v[156:157], v[160:161]
    v_pk_fma_f32 v[94:95], v[94:95], v[156:157], v[160:161]
    v_pk_fma_f32 v[96:97], v[96:97], v[156:157], v[160:161]
    v_pk_fma_f32 v[98:99], v[98:99], v[156:157], v[160:161]
    v_pk_fma_f32 v[100:101], v[100:101], v[156:157], v[160:161]
    v_pk_fma_f32 v[102:103], v[102:103], v[156:157], v[160:161]
    v_pk_mul_f32 v[104:105], v[104:105], v[158:159]
    v_pk_mul_f32 v[106:107], v[106:107], v[158:159]
    v_pk_mul_f32 v[108:109], v[108:109], v[158:159]
    v_pk_mul_f32 v[110:111], v[110:111], v[158:159]
    v_pk_mul_f32 v[112:113], v[112:113], v[158:159]
    v_pk_mul_f32 v[114:115], v[114:115], v[158:159]
    v_pk_mul_f32 v[116:117], v[116:117], v[158:159]
    v_pk_mul_f32 v[118:119], v[118:119], v[158:159]
    v_pk_mul_f32 v[120:121], v[120:121], v[156:157]
    v_pk_mul_f32 v[122:123], v[122:123], v[156:157]
    v_pk_mul_f32 v[124:125], v[124:125], v[156:157]
    v_pk_mul_f32 v[126:127], v[126:127], v[156:157]
    v_pk_mul_f32 v[128:129], v[128:129], v[156:157]
    v_pk_mul_f32 v[130:131], v[130:131], v[156:157]
    v_pk_mul_f32 v[132:133], v[132:133], v[156:157]
    v_pk_mul_f32 v[134:135], v[134:135], v[156:157]
    v_pk_mul_f32 v[136:137], v[136:137], v[158:159]
    v_pk_mul_f32 v[138:139], v[138:139], v[158:159]
    v_pk_mul_f32 v[140:141], v[140:141], v[158:159]
    v_pk_mul_f32 v[142:143], v[142:143], v[158:159]
    v_pk_mul_f32 v[144:145], v[144:145], v[158:159]
    v_pk_mul_f32 v[146:147], v[146:147], v[158:159]
    v_pk_mul_f32 v[148:149], v[148:149], v[158:159]
    v_pk_mul_f32 v[150:151], v[150:151], v[158:159]
    v_max3_u32 v1, v32, v33, v34
    v_max3_u32 v2, v35, v36, v37
    v_max3_u32 v1, v1, v38, v39
    v_max_u32 v1, v1, v2
    v_cmp_eq_u32 vcc, -1, v1
    s_cbranch_vccnz OR_76
OB_84:
    s_waitcnt lgkmcnt(0)
    v_mfma_f32_32x32x16_bf16 v[88:103], v[16:19], v[32:35], v[88:103]
    s_waitcnt vmcnt(16)
    ds_read_b64_tr_b16 v[24:25], v152 offset:4096
    ds_read_b64_tr_b16 v[26:27], v152 offset:5120
    ds_read_b64_tr_b16 v[28:29], v153 offset:4096
    ds_read_b64_tr_b16 v[30:31], v153 offset:5120
    v_mfma_f32_32x32x16_bf16 v[104:119], v[16:19], v[36:39], v[104:119]
    buffer_load_dwordx4 v[80:83], v8, s[4:7], s70 offen offset:2048 sc1
    v_mfma_f32_32x32x16_bf16 v[120:135], v[20:23], v[32:35], v[120:135]
    buffer_load_dwordx4 v[84:87], v167, s[4:7], s70 offen offset:2048 sc1
    v_mfma_f32_32x32x16_bf16 v[136:151], v[20:23], v[36:39], v[136:151]
    v_max3_u32 v1, v40, v41, v42
    v_max3_u32 v2, v43, v44, v45
    v_max3_u32 v1, v1, v46, v47
    v_max_u32 v1, v1, v2
    v_cmp_eq_u32 vcc, -1, v1
    s_cbranch_vccnz OR_77
OB_85:
    s_waitcnt lgkmcnt(0)
    v_mfma_f32_32x32x16_bf16 v[88:103], v[24:27], v[40:43], v[88:103]
    s_waitcnt vmcnt(14)
    ds_read_b64_tr_b16 v[16:17], v152 offset:6144
    ds_read_b64_tr_b16 v[18:19], v152 offset:7168
    ds_read_b64_tr_b16 v[20:21], v153 offset:6144
    ds_read_b64_tr_b16 v[22:23], v153 offset:7168
    v_mfma_f32_32x32x16_bf16 v[104:119], v[24:27], v[44:47], v[104:119]
    buffer_load_dwordx4 v[32:35], v8, s[4:7], s70 offen offset:3072 sc1
    v_mfma_f32_32x32x16_bf16 v[120:135], v[28:31], v[40:43], v[120:135]
    buffer_load_dwordx4 v[36:39], v167, s[4:7], s70 offen offset:3072 sc1
    v_mfma_f32_32x32x16_bf16 v[136:151], v[28:31], v[44:47], v[136:151]
    v_max3_u32 v1, v48, v49, v50
    v_max3_u32 v2, v51, v52, v53
    v_max3_u32 v1, v1, v54, v55
    v_max_u32 v1, v1, v2
    v_cmp_eq_u32 vcc, -1, v1
    s_cbranch_vccnz OR_78
OB_86:
    s_waitcnt lgkmcnt(0)
    v_mfma_f32_32x32x16_bf16 v[88:103], v[16:19], v[48:51], v[88:103]
    s_waitcnt vmcnt(12)
    ds_read_b64_tr_b16 v[24:25], v152 offset:8192
    ds_read_b64_tr_b16 v[26:27], v152 offset:9216
    ds_read_b64_tr_b16 v[28:29], v153 offset:8192
    ds_read_b64_tr_b16 v[30:31], v153 offset:9216
    v_mfma_f32_32x32x16_bf16 v[104:119], v[16:19], v[52:55], v[104:119]
    v_mfma_f32_32x32x16_bf16 v[120:135], v[20:23], v[48:51], v[120:135]
    v_mfma_f32_32x32x16_bf16 v[136:151], v[20:23], v[52:55], v[136:151]
    v_max3_u32 v1, v56, v57, v58
    v_max3_u32 v2, v59, v60, v61
    v_max3_u32 v1, v1, v62, v63
    v_max_u32 v1, v1, v2
    v_cmp_eq_u32 vcc, -1, v1
    s_cbranch_vccnz OR_79
OB_87:
    s_waitcnt lgkmcnt(0)
    v_mfma_f32_32x32x16_bf16 v[88:103], v[24:27], v[56:59], v[88:103]
    s_waitcnt vmcnt(8)
    ds_read_b64_tr_b16 v[16:17], v152 offset:10240
    ds_read_b64_tr_b16 v[18:19], v152 offset:11264
    ds_read_b64_tr_b16 v[20:21], v153 offset:10240
    ds_read_b64_tr_b16 v[22:23], v153 offset:11264
    v_mfma_f32_32x32x16_bf16 v[104:119], v[24:27], v[60:63], v[104:119]
    v_mfma_f32_32x32x16_bf16 v[120:135], v[28:31], v[56:59], v[120:135]
    v_mfma_f32_32x32x16_bf16 v[136:151], v[28:31], v[60:63], v[136:151]
    v_max3_u32 v1, v64, v65, v66
    v_max3_u32 v2, v67, v68, v69
    v_max3_u32 v1, v1, v70, v71
    v_max_u32 v1, v1, v2
    v_cmp_eq_u32 vcc, -1, v1
    s_cbranch_vccnz OR_80
OB_88:
    s_waitcnt lgkmcnt(0)
    v_mfma_f32_32x32x16_bf16 v[88:103], v[16:19], v[64:67], v[88:103]
    s_waitcnt vmcnt(4)
    ds_read_b64_tr_b16 v[24:25], v152 offset:12288
    ds_read_b64_tr_b16 v[26:27], v152 offset:13312
    ds_read_b64_tr_b16 v[28:29], v153 offset:12288
    ds_read_b64_tr_b16 v[30:31], v153 offset:13312
    v_mfma_f32_32x32x16_bf16 v[104:119], v[16:19], v[68:71], v[104:119]
    v_mfma_f32_32x32x16_bf16 v[120:135], v[20:23], v[64:67], v[120:135]
    v_mfma_f32_32x32x16_bf16 v[136:151], v[20:23], v[68:71], v[136:151]
    v_max3_u32 v1, v72, v73, v74
    v_max3_u32 v2, v75, v76, v77
    v_max3_u32 v1, v1, v78, v79
    v_max_u32 v1, v1, v2
    v_cmp_eq_u32 vcc, -1, v1
    s_cbranch_vccnz OR_81
OB_89:
    s_waitcnt lgkmcnt(0)
    v_mfma_f32_32x32x16_bf16 v[88:103], v[24:27], v[72:75], v[88:103]
    s_waitcnt vmcnt(2)
    ds_read_b64_tr_b16 v[16:17], v152 offset:14336
    ds_read_b64_tr_b16 v[18:19], v152 offset:15360
    ds_read_b64_tr_b16 v[20:21], v153 offset:14336
    ds_read_b64_tr_b16 v[22:23], v153 offset:15360
    v_mfma_f32_32x32x16_bf16 v[104:119], v[24:27], v[76:79], v[104:119]
    v_mfma_f32_32x32x16_bf16 v[120:135], v[28:31], v[72:75], v[120:135]
    v_mfma_f32_32x32x16_bf16 v[136:151], v[28:31], v[76:79], v[136:151]
    v_max3_u32 v1, v80, v81, v82
    v_max3_u32 v2, v83, v84, v85
    v_max3_u32 v1, v1, v86, v87
    v_max_u32 v1, v1, v2
    v_cmp_eq_u32 vcc, -1, v1
    s_cbranch_vccnz OR_82
OB_90:
    s_waitcnt lgkmcnt(0)
    v_mfma_f32_32x32x16_bf16 v[88:103], v[16:19], v[80:83], v[88:103]
    s_waitcnt vmcnt(0)
    ds_read_b64_tr_b16 v[24:25], v152 offset:16384
    ds_read_b64_tr_b16 v[26:27], v152 offset:17408
    ds_read_b64_tr_b16 v[28:29], v153 offset:16384
    ds_read_b64_tr_b16 v[30:31], v153 offset:17408
    v_mfma_f32_32x32x16_bf16 v[104:119], v[16:19], v[84:87], v[104:119]
    v_mfma_f32_32x32x16_bf16 v[120:135], v[20:23], v[80:83], v[120:135]
    v_mfma_f32_32x32x16_bf16 v[136:151], v[20:23], v[84:87], v[136:151]
    v_max3_u32 v1, v32, v33, v34
    v_max3_u32 v2, v35, v36, v37
    v_max3_u32 v1, v1, v38, v39
    v_max_u32 v1, v1, v2
    v_cmp_eq_u32 vcc, -1, v1
    s_cbranch_vccnz OR_83
OB_91:
    s_waitcnt lgkmcnt(0)
    v_mfma_f32_32x32x16_bf16 v[88:103], v[24:27], v[32:35], v[88:103]
    v_mfma_f32_32x32x16_bf16 v[104:119], v[24:27], v[36:39], v[104:119]
    v_mfma_f32_32x32x16_bf16 v[120:135], v[28:31], v[32:35], v[120:135]
    v_mfma_f32_32x32x16_bf16 v[136:151], v[28:31], v[36:39], v[136:151]
    s_setprio 3
    v_lshl_add_u32 v1, v0, 4, s58
    s_nop 10
    ds_write_b128 v1, v[104:107] offset:0
    ds_write_b128 v1, v[108:111] offset:1024
    ds_write_b128 v1, v[112:115] offset:2048
    ds_write_b128 v1, v[116:119] offset:3072
    ds_write_b128 v1, v[120:123] offset:4096
    ds_write_b128 v1, v[124:127] offset:5120
    ds_write_b128 v1, v[128:131] offset:6144
    ds_write_b128 v1, v[132:135] offset:7168
    ds_write_b128 v1, v[136:139] offset:8192
    ds_write_b128 v1, v[140:143] offset:9216
    ds_write_b128 v1, v[144:147] offset:10240
    ds_write_b128 v1, v[148:151] offset:11264
    v_mov_b32 v2, 5
    ds_write_b32 v14, v2
    s_xor_b32 s52, s54, 1
    s_mul_i32 s52, s52, 18432
    s_add_u32 s52, s52, 81920
    v_lshl_add_u32 v24, v0, 4, s52
    s_xor_b32 s52, s54, 2
    s_mul_i32 s52, s52, 18432
    s_add_u32 s52, s52, 86016
    v_lshl_add_u32 v25, v0, 4, s52
    s_xor_b32 s52, s54, 3
    s_mul_i32 s52, s52, 18432
    s_add_u32 s52, s52, 90112
    v_lshl_add_u32 v26, v0, 4, s52
W_96:
    ds_read_b32 v2, v15
    s_waitcnt lgkmcnt(0)
    v_cmp_gt_u32 vcc, 5, v2
    s_cbranch_vccz W_97
    s_sub_u32 s48, s48, 1
    s_cbranch_scc0 W_96
    s_mov_b32 s48, 0
W_97:
    ds_read_b128 v[104:107], v24 offset:0
    ds_read_b128 v[108:111], v24 offset:1024
    ds_read_b128 v[112:115], v24 offset:2048
    ds_read_b128 v[116:119], v24 offset:3072
    ds_read_b128 v[120:123], v25 offset:0
    ds_read_b128 v[124:127], v25 offset:1024
    ds_read_b128 v[128:131], v25 offset:2048
    ds_read_b128 v[132:135], v25 offset:3072
    ds_read_b128 v[136:139], v26 offset:0
    ds_read_b128 v[140:143], v26 offset:1024
    ds_read_b128 v[144:147], v26 offset:2048
    ds_read_b128 v[148:151], v26 offset:3072
    v_mov_b32 v2, 6
    ds_write_b32 v14, v2
    s_waitcnt lgkmcnt(9)
    v_pk_add_f32 v[88:89], v[88:89], v[104:105]
    v_pk_add_f32 v[90:91], v[90:91], v[106:107]
    v_pk_add_f32 v[92:93], v[92:93], v[108:109]
    v_pk_add_f32 v[94:95], v[94:95], v[110:111]
    v_pk_add_f32 v[96:97], v[96:97], v[112:113]
    v_pk_add_f32 v[98:99], v[98:99], v[114:115]
    v_pk_add_f32 v[100:101], v[100:101], v[116:117]
    v_pk_add_f32 v[102:103], v[102:103], v[118:119]
    s_waitcnt lgkmcnt(5)
    v_pk_add_f32 v[88:89], v[88:89], v[120:121]
    v_pk_add_f32 v[90:91], v[90:91], v[122:123]
    v_pk_add_f32 v[92:93], v[92:93], v[124:125]
    v_pk_add_f32 v[94:95], v[94:95], v[126:127]
    v_pk_add_f32 v[96:97], v[96:97], v[128:129]
    v_pk_add_f32 v[98:99], v[98:99], v[130:131]
    v_pk_add_f32 v[100:101], v[100:101], v[132:133]
    v_pk_add_f32 v[102:103], v[102:103], v[134:135]
    s_waitcnt lgkmcnt(1)
    v_pk_add_f32 v[88:89], v[88:89], v[136:137]
    v_pk_add_f32 v[90:91], v[90:91], v[138:139]
    v_pk_add_f32 v[92:93], v[92:93], v[140:141]
    v_pk_add_f32 v[94:95], v[94:95], v[142:143]
    v_pk_add_f32 v[96:97], v[96:97], v[144:145]
    v_pk_add_f32 v[98:99], v[98:99], v[146:147]
    v_pk_add_f32 v[100:101], v[100:101], v[148:149]
    v_pk_add_f32 v[102:103], v[102:103], v[150:151]
    v_cvt_pk_bf16_f32 v16, v88, v89
    v_cvt_pk_bf16_f32 v17, v90, v91
    v_cvt_pk_bf16_f32 v18, v92, v93
    v_cvt_pk_bf16_f32 v19, v94, v95
    v_cvt_pk_bf16_f32 v20, v96, v97
    v_cvt_pk_bf16_f32 v21, v98, v99
    v_cvt_pk_bf16_f32 v22, v100, v101
    v_cvt_pk_bf16_f32 v23, v102, v103
    v_and_b32 v1, 31, v0
    v_lshlrev_b32 v1, 10, v1
    v_lshrrev_b32 v2, 5, v0
    v_lshl_add_u32 v1, v2, 4, v1
    s_mov_b32 s52, s79
    v_permlane32_swap_b32 v16, v18
    v_permlane32_swap_b32 v17, v19
    v_permlane32_swap_b32 v20, v22
    v_permlane32_swap_b32 v21, v23
    s_nop 1
    buffer_store_dwordx4 v[16:19], v1, s[12:15], s52 offen
    buffer_store_dwordx4 v[20:23], v1, s[12:15], s52 offen offset:32
    s_lshl4_add_u32 s52, s2, s54
    s_cmp_lg_u32 s52, 0
    s_cbranch_scc1 EP_98
    s_mov_b32 s52, 13651968
    v_mov_b32 v1, s49
    v_cmp_eq_u32 vcc, 0, v0
    v_mov_b32 v2, 0x7ffffff0
    s_nop 0
    v_cndmask_b32 v2, v2, 0, vcc
    s_waitcnt vmcnt(0)
    buffer_store_dword v1, v2, s[4:7], s52 offen sc1
EP_98:
    s_endpgm
UW_74:
    s_add_u32 m0, s58, 6144
    s_add_u32 s52, s60, 65536
    buffer_load_dwordx4 v4, s[8:11], s60 offen lds
    buffer_load_dwordx4 v164, s[8:11], s60 offen offset:1024 lds
    s_cmp_eq_u32 s52, s62
    s_cselect_b32 s60, s61, s52
    s_add_u32 m0, s58, 8192
    s_add_u32 s52, s60, 65536
    buffer_load_dwordx4 v4, s[8:11], s60 offen lds
    buffer_load_dwordx4 v164, s[8:11], s60 offen offset:1024 lds
    s_cmp_eq_u32 s52, s62
    s_cselect_b32 s60, s61, s52
    s_add_u32 m0, s58, 10240
    s_add_u32 s52, s60, 65536
    buffer_load_dwordx4 v4, s[8:11], s60 offen lds
    buffer_load_dwordx4 v164, s[8:11], s60 offen offset:1024 lds
    s_cmp_eq_u32 s52, s62
    s_cselect_b32 s60, s61, s52
    s_add_u32 m0, s58, 12288
    s_add_u32 s52, s60, 65536
    buffer_load_dwordx4 v4, s[8:11], s60 offen lds
    buffer_load_dwordx4 v164, s[8:11], s60 offen offset:1024 lds
    s_cmp_eq_u32 s52, s62
    s_cselect_b32 s60, s61, s52
    s_add_u32 m0, s58, 14336
    s_add_u32 s52, s60, 65536
    buffer_load_dwordx4 v4, s[8:11], s60 offen lds
    buffer_load_dwordx4 v164, s[8:11], s60 offen offset:1024 lds
    s_cmp_eq_u32 s52, s62
    s_cselect_b32 s60, s61, s52
GW_99:
    buffer_load_dword v9, v155, s[4:7], 0 offen sc1
    s_waitcnt vmcnt(0)
    v_cmp_ne_u32 vcc, s49, v9
    s_cbranch_vccz GW_100
    s_sleep 4
    s_sub_u32 s48, s48, 1
    s_cbranch_scc0 GW_99
    s_mov_b32 s48, 0
GW_100:
    v_mov_b32 v9, 0x7ffffff0
    buffer_load_dwordx4 v[32:35], v162, s[4:7], s63 offen sc1
    s_add_u32 s53, s63, 1024
    buffer_load_dwordx4 v[36:39], v163, s[4:7], s63 offen sc1
    s_cmp_eq_u32 s53, s73
    s_cselect_b32 s63, s71, s53
    buffer_load_dwordx4 v[40:43], v162, s[4:7], s63 offen sc1
    s_add_u32 s53, s63, 1024
    buffer_load_dwordx4 v[44:47], v163, s[4:7], s63 offen sc1
    s_cmp_eq_u32 s53, s73
    s_cselect_b32 s63, s71, s53
    buffer_load_dwordx4 v[48:51], v162, s[4:7], s63 offen sc1
    s_add_u32 s53, s63, 1024
    buffer_load_dwordx4 v[52:55], v163, s[4:7], s63 offen sc1
    s_cmp_eq_u32 s53, s73
    s_cselect_b32 s63, s71, s53
    buffer_load_dword v1, v9, s[4:7], 0 offen
    buffer_load_dword v1, v9, s[4:7], 0 offen
    buffer_load_dwordx4 v[56:59], v162, s[4:7], s63 offen sc1
    s_add_u32 s53, s63, 1024
    buffer_load_dwordx4 v[60:63], v163, s[4:7], s63 offen sc1
    s_cmp_eq_u32 s53, s73
    s_cselect_b32 s63, s71, s53
    buffer_load_dword v1, v9, s[4:7], 0 offen
    buffer_load_dword v1, v9, s[4:7], 0 offen
    buffer_load_dwordx4 v[64:67], v162, s[4:7], s63 offen sc1
    s_add_u32 s53, s63, 1024
    buffer_load_dwordx4 v[68:71], v163, s[4:7], s63 offen sc1
    s_cmp_eq_u32 s53, s73
    s_cselect_b32 s63, s71, s53
    buffer_load_dword v1, v9, s[4:7], 0 offen
    buffer_load_dword v1, v9, s[4:7], 0 offen
    buffer_load_dwordx4 v[72:75], v162, s[4:7], s63 offen sc1
    s_add_u32 s53, s63, 1024
    buffer_load_dwordx4 v[76:79], v163, s[4:7], s63 offen sc1
    s_cmp_eq_u32 s53, s73
    s_cselect_b32 s63, s71, s53
    buffer_load_dword v1, v9, s[4:7], 0 offen
    buffer_load_dword v1, v9, s[4:7], 0 offen
    buffer_load_dword v1, v9, s[4:7], 0 offen
    buffer_load_dword v1, v9, s[4:7], 0 offen
    s_branch UW_75
OS_94:
GW_101:
    buffer_load_dword v155, v154, s[4:7], 0 offen sc1
    s_waitcnt vmcnt(0)
    v_cmp_ne_u32 vcc, s49, v155
    s_cbranch_vccz GW_102
    s_sleep 2
    s_sub_u32 s48, s48, 1
    s_cbranch_scc0 GW_101
    s_mov_b32 s48, 0
GW_102:
    s_branch OJ_95
OR_76:
    s_setprio 0
OL_103:
    s_sleep 4
    buffer_load_dwordx4 v[32:35], v8, s[4:7], s69 offen offset:0 sc1
    buffer_load_dwordx4 v[36:39], v167, s[4:7], s69 offen offset:0 sc1
    buffer_load_dwordx4 v[40:43], v8, s[4:7], s69 offen offset:1024 sc1
    buffer_load_dwordx4 v[44:47], v167, s[4:7], s69 offen offset:1024 sc1
    buffer_load_dwordx4 v[48:51], v8, s[4:7], s69 offen offset:2048 sc1
    buffer_load_dwordx4 v[52:55], v167, s[4:7], s69 offen offset:2048 sc1
    buffer_load_dwordx4 v[56:59], v8, s[4:7], s69 offen offset:3072 sc1
    buffer_load_dwordx4 v[60:63], v167, s[4:7], s69 offen offset:3072 sc1
    buffer_load_dwordx4 v[64:67], v8, s[4:7], s70 offen offset:0 sc1
    buffer_load_dwordx4 v[68:71], v167, s[4:7], s70 offen offset:0 sc1
    buffer_load_dwordx4 v[72:75], v8, s[4:7], s70 offen offset:1024 sc1
    buffer_load_dwordx4 v[76:79], v167, s[4:7], s70 offen offset:1024 sc1
    s_waitcnt vmcnt(0)
    v_max3_u32 v1, v32, v33, v34
    v_max3_u32 v2, v35, v36, v37
    v_max3_u32 v1, v1, v38, v39
    v_max_u32 v1, v1, v2
    v_cmp_eq_u32 vcc, -1, v1
    s_sub_u32 s48, s48, 1
    s_cselect_b64 vcc, 0, vcc
    s_max_i32 s48, s48, 0
    s_cbranch_vccnz OL_103
    s_setprio 3
    s_branch OB_84
OR_77:
    s_setprio 0
OL_104:
    s_sleep 4
    buffer_load_dwordx4 v[40:43], v8, s[4:7], s69 offen offset:1024 sc1
    buffer_load_dwordx4 v[44:47], v167, s[4:7], s69 offen offset:1024 sc1
    buffer_load_dwordx4 v[48:51], v8, s[4:7], s69 offen offset:2048 sc1
    buffer_load_dwordx4 v[52:55], v167, s[4:7], s69 offen offset:2048 sc1
    buffer_load_dwordx4 v[56:59], v8, s[4:7], s69 offen offset:3072 sc1
    buffer_load_dwordx4 v[60:63], v167, s[4:7], s69 offen offset:3072 sc1
    buffer_load_dwordx4 v[64:67], v8, s[4:7], s70 offen offset:0 sc1
    buffer_load_dwordx4 v[68:71], v167, s[4:7], s70 offen offset:0 sc1
    buffer_load_dwordx4 v[72:75], v8, s[4:7], s70 offen offset:1024 sc1
    buffer_load_dwordx4 v[76:79], v167, s[4:7], s70 offen offset:1024 sc1
    buffer_load_dwordx4 v[80:83], v8, s[4:7], s70 offen offset:2048 sc1
    buffer_load_dwordx4 v[84:87], v167, s[4:7], s70 offen offset:2048 sc1
    s_waitcnt vmcnt(0)
    v_max3_u32 v1, v40, v41, v42
    v_max3_u32 v2, v43, v44, v45
    v_max3_u32 v1, v1, v46, v47
    v_max_u32 v1, v1, v2
    v_cmp_eq_u32 vcc, -1, v1
    s_sub_u32 s48, s48, 1
    s_cselect_b64 vcc, 0, vcc
    s_max_i32 s48, s48, 0
    s_cbranch_vccnz OL_104
    s_setprio 3
    s_branch OB_85
OR_78:
    s_setprio 0
OL_105:
    s_sleep 4
    buffer_load_dwordx4 v[48:51], v8, s[4:7], s69 offen offset:2048 sc1
    buffer_load_dwordx4 v[52:55], v167, s[4:7], s69 offen offset:2048 sc1
    buffer_load_dwordx4 v[56:59], v8, s[4:7], s69 offen offset:3072 sc1
    buffer_load_dwordx4 v[60:63], v167, s[4:7], s69 offen offset:3072 sc1
    buffer_load_dwordx4 v[64:67], v8, s[4:7], s70 offen offset:0 sc1
    buffer_load_dwordx4 v[68:71], v167, s[4:7], s70 offen offset:0 sc1
    buffer_load_dwordx4 v[72:75], v8, s[4:7], s70 offen offset:1024 sc1
    buffer_load_dwordx4 v[76:79], v167, s[4:7], s70 offen offset:1024 sc1
    buffer_load_dwordx4 v[80:83], v8, s[4:7], s70 offen offset:2048 sc1
    buffer_load_dwordx4 v[84:87], v167, s[4:7], s70 offen offset:2048 sc1
    buffer_load_dwordx4 v[32:35], v8, s[4:7], s70 offen offset:3072 sc1
    buffer_load_dwordx4 v[36:39], v167, s[4:7], s70 offen offset:3072 sc1
    s_waitcnt vmcnt(0)
    v_max3_u32 v1, v48, v49, v50
    v_max3_u32 v2, v51, v52, v53
    v_max3_u32 v1, v1, v54, v55
    v_max_u32 v1, v1, v2
    v_cmp_eq_u32 vcc, -1, v1
    s_sub_u32 s48, s48, 1
    s_cselect_b64 vcc, 0, vcc
    s_max_i32 s48, s48, 0
    s_cbranch_vccnz OL_105
    s_setprio 3
    s_branch OB_86
OR_79:
    s_setprio 0
OL_106:
    s_sleep 4
    buffer_load_dwordx4 v[56:59], v8, s[4:7], s69 offen offset:3072 sc1
    buffer_load_dwordx4 v[60:63], v167, s[4:7], s69 offen offset:3072 sc1
    buffer_load_dwordx4 v[64:67], v8, s[4:7], s70 offen offset:0 sc1
    buffer_load_dwordx4 v[68:71], v167, s[4:7], s70 offen offset:0 sc1
    buffer_load_dwordx4 v[72:75], v8, s[4:7], s70 offen offset:1024 sc1
    buffer_load_dwordx4 v[76:79], v167, s[4:7], s70 offen offset:1024 sc1
    buffer_load_dwordx4 v[80:83], v8, s[4:7], s70 offen offset:2048 sc1
    buffer_load_dwordx4 v[84:87], v167, s[4:7], s70 offen offset:2048 sc1
    buffer_load_dwordx4 v[32:35], v8, s[4:7], s70 offen offset:3072 sc1
    buffer_load_dwordx4 v[36:39], v167, s[4:7], s70 offen offset:3072 sc1
    s_waitcnt vmcnt(0)
    v_max3_u32 v1, v56, v57, v58
    v_max3_u32 v2, v59, v60, v61
    v_max3_u32 v1, v1, v62, v63
    v_max_u32 v1, v1, v2
    v_cmp_eq_u32 vcc, -1, v1
    s_sub_u32 s48, s48, 1
    s_cselect_b64 vcc, 0, vcc
    s_max_i32 s48, s48, 0
    s_cbranch_vccnz OL_106
    s_setprio 3
    s_branch OB_87
OR_80:
    s_setprio 0
OL_107:
    s_sleep 4
    buffer_load_dwordx4 v[64:67], v8, s[4:7], s70 offen offset:0 sc1
    buffer_load_dwordx4 v[68:71], v167, s[4:7], s70 offen offset:0 sc1
    buffer_load_dwordx4 v[72:75], v8, s[4:7], s70 offen offset:1024 sc1
    buffer_load_dwordx4 v[76:79], v167, s[4:7], s70 offen offset:1024 sc1
    buffer_load_dwordx4 v[80:83], v8, s[4:7], s70 offen offset:2048 sc1
    buffer_load_dwordx4 v[84:87], v167, s[4:7], s70 offen offset:2048 sc1
    buffer_load_dwordx4 v[32:35], v8, s[4:7], s70 offen offset:3072 sc1
    buffer_load_dwordx4 v[36:39], v167, s[4:7], s70 offen offset:3072 sc1
    s_waitcnt vmcnt(0)
    v_max3_u32 v1, v64, v65, v66
    v_max3_u32 v2, v67, v68, v69
    v_max3_u32 v1, v1, v70, v71
    v_max_u32 v1, v1, v2
    v_cmp_eq_u32 vcc, -1, v1
    s_sub_u32 s48, s48, 1
    s_cselect_b64 vcc, 0, vcc
    s_max_i32 s48, s48, 0
    s_cbranch_vccnz OL_107
    s_setprio 3
    s_branch OB_88
OR_81:
    s_setprio 0
OL_108:
    s_sleep 4
    buffer_load_dwordx4 v[72:75], v8, s[4:7], s70 offen offset:1024 sc1
    buffer_load_dwordx4 v[76:79], v167, s[4:7], s70 offen offset:1024 sc1
    buffer_load_dwordx4 v[80:83], v8, s[4:7], s70 offen offset:2048 sc1
    buffer_load_dwordx4 v[84:87], v167, s[4:7], s70 offen offset:2048 sc1
    buffer_load_dwordx4 v[32:35], v8, s[4:7], s70 offen offset:3072 sc1
    buffer_load_dwordx4 v[36:39], v167, s[4:7], s70 offen offset:3072 sc1
    s_waitcnt vmcnt(0)
    v_max3_u32 v1, v72, v73, v74
    v_max3_u32 v2, v75, v76, v77
    v_max3_u32 v1, v1, v78, v79
    v_max_u32 v1, v1, v2
    v_cmp_eq_u32 vcc, -1, v1
    s_sub_u32 s48, s48, 1
    s_cselect_b64 vcc, 0, vcc
    s_max_i32 s48, s48, 0
    s_cbranch_vccnz OL_108
    s_setprio 3
    s_branch OB_89
OR_82:
    s_setprio 0
OL_109:
    s_sleep 4
    buffer_load_dwordx4 v[80:83], v8, s[4:7], s70 offen offset:2048 sc1
    buffer_load_dwordx4 v[84:87], v167, s[4:7], s70 offen offset:2048 sc1
    buffer_load_dwordx4 v[32:35], v8, s[4:7], s70 offen offset:3072 sc1
    buffer_load_dwordx4 v[36:39], v167, s[4:7], s70 offen offset:3072 sc1
    s_waitcnt vmcnt(0)
    v_max3_u32 v1, v80, v81, v82
    v_max3_u32 v2, v83, v84, v85
    v_max3_u32 v1, v1, v86, v87
    v_max_u32 v1, v1, v2
    v_cmp_eq_u32 vcc, -1, v1
    s_sub_u32 s48, s48, 1
    s_cselect_b64 vcc, 0, vcc
    s_max_i32 s48, s48, 0
    s_cbranch_vccnz OL_109
    s_setprio 3
    s_branch OB_90
OR_83:
    s_setprio 0
OL_110:
    s_sleep 4
    buffer_load_dwordx4 v[32:35], v8, s[4:7], s70 offen offset:3072 sc1
    buffer_load_dwordx4 v[36:39], v167, s[4:7], s70 offen offset:3072 sc1
    s_waitcnt vmcnt(0)
    v_max3_u32 v1, v32, v33, v34
    v_max3_u32 v2, v35, v36, v37
    v_max3_u32 v1, v1, v38, v39
    v_max_u32 v1, v1, v2
    v_cmp_eq_u32 vcc, -1, v1
    s_sub_u32 s48, s48, 1
    s_cselect_b64 vcc, 0, vcc
    s_max_i32 s48, s48, 0
    s_cbranch_vccnz OL_110
    s_setprio 3
    s_branch OB_91
QF_15:
W_111:
    ds_read_b32 v7, v3
    s_waitcnt lgkmcnt(0)
    v_cmp_gt_u32 vcc, 1, v7
    s_cbranch_vccz W_112
    s_sub_u32 s48, s48, 1
    s_cbranch_scc0 W_111
    s_mov_b32 s48, 0
W_112:
    v_cmp_eq_u32 vcc, 1, v7
    s_cbranch_vccnz QF_16
    v_cvt_pk_bf16_f32 v64, v124, v125
    v_cvt_pk_bf16_f32 v65, v126, v127
    v_cvt_pk_bf16_f32 v66, v128, v129
    v_cvt_pk_bf16_f32 v67, v130, v131
    v_cvt_pk_bf16_f32 v68, v132, v133
    v_cvt_pk_bf16_f32 v69, v134, v135
    v_cvt_pk_bf16_f32 v70, v136, v137
    v_cvt_pk_bf16_f32 v71, v138, v139
    s_nop 0
    v_permlane16_swap_b32 v64, v66
    v_permlane16_swap_b32 v65, v67
    v_permlane16_swap_b32 v68, v70
    v_permlane16_swap_b32 v69, v71
    buffer_store_dwordx4 v[64:67], v4, s[4:7], s68 offen sc1
    buffer_store_dwordx4 v[68:71], v4, s[4:7], s68 offen offset:2048 sc1
    v_cvt_pk_bf16_f32 v72, v140, v141
    v_cvt_pk_bf16_f32 v73, v142, v143
    v_cvt_pk_bf16_f32 v74, v144, v145
    v_cvt_pk_bf16_f32 v75, v146, v147
    v_cvt_pk_bf16_f32 v76, v148, v149
    v_cvt_pk_bf16_f32 v77, v150, v151
    v_cvt_pk_bf16_f32 v78, v152, v153
    v_cvt_pk_bf16_f32 v79, v154, v155
    s_nop 0
    v_permlane16_swap_b32 v72, v74
    v_permlane16_swap_b32 v73, v75
    v_permlane16_swap_b32 v76, v78
    v_permlane16_swap_b32 v77, v79
    buffer_store_dwordx4 v[72:75], v6, s[4:7], s68 offen offset:1024 sc1
    buffer_store_dwordx4 v[76:79], v6, s[4:7], s68 offen offset:3072 sc1
    v_pk_mul_f32 v[108:109], v[108:109], s[52:53]
    v_pk_mul_f32 v[110:111], v[110:111], s[52:53]
    v_pk_mul_f32 v[112:113], v[112:113], s[52:53]
    v_pk_mul_f32 v[114:115], v[114:115], s[52:53]
    v_pk_mul_f32 v[116:117], v[116:117], s[52:53]
    v_pk_mul_f32 v[118:119], v[118:119], s[52:53]
    v_pk_mul_f32 v[120:121], v[120:121], s[52:53]
    v_pk_mul_f32 v[122:123], v[122:123], s[52:53]
    v_cvt_pk_bf16_f32 v80, v108, v109
    v_cvt_pk_bf16_f32 v81, v110, v111
    v_cvt_pk_bf16_f32 v82, v112, v113
    v_cvt_pk_bf16_f32 v83, v114, v115
    v_cvt_pk_bf16_f32 v84, v116, v117
    v_cvt_pk_bf16_f32 v85, v118, v119
    v_cvt_pk_bf16_f32 v86, v120, v121
    v_cvt_pk_bf16_f32 v87, v122, v123
    s_nop 0
    v_permlane16_swap_b32 v80, v82
    v_permlane16_swap_b32 v81, v83
    v_permlane16_swap_b32 v84, v86
    v_permlane16_swap_b32 v85, v87
    buffer_store_dwordx4 v[80:83], v4, s[4:7], s69 offen sc1
    buffer_store_dwordx4 v[84:87], v4, s[4:7], s69 offen offset:1024 sc1
    v_mov_b32 v1, s49
    v_cmp_eq_u32 vcc, 0, v0
    v_mov_b32 v2, 0x7ffffff0
    s_nop 0
    v_cndmask_b32 v2, v2, 0, vcc
    s_waitcnt vmcnt(0)
    buffer_store_dword v1, v2, s[4:7], s70 offen sc1
    v_mov_b32 v1, 10
    ds_write_b32 v104, v1
    s_waitcnt lgkmcnt(0)
    s_branch M_attn
M_exit:
    s_endpgm
CODE_END:
.section .rodata,"a"
.p2align 6
.amdhsa_kernel gated_mix__softmax_full_mha__mixer_token_mlp__prompt_kernel
  .amdhsa_next_free_vgpr 168
  .amdhsa_next_free_sgpr 102
  .amdhsa_accum_offset 168
  .amdhsa_group_segment_fixed_size 0
  .amdhsa_kernarg_size 96
  .amdhsa_user_sgpr_count 2
  .amdhsa_user_sgpr_kernarg_segment_ptr 1
  .amdhsa_system_sgpr_workgroup_id_x 1
.end_amdhsa_kernel
```
